```python
import torch

def _softmax(x, axis=-1):
    return torch.softmax(x, dim=axis)
def _gelu(x):
    return torch.nn.functional.gelu(x, approximate="tanh")
def _silu(x):
    return torch.nn.functional.silu(x)
def _sigmoid(x):
    return torch.sigmoid(x)
def _layernorm(x, axis=-1, eps=1e-5):
    m = x.mean(dim=axis, keepdim=True)
    v = x.var(dim=axis, keepdim=True, unbiased=False)
    return (x - m) / torch.sqrt(v + eps)
def _scatter_add(tgt, idx, src, axis=0):
    return tgt.clone().index_add_(axis, idx, src)
def _segment_sum(src, seg, n):
    out = torch.zeros((n,) + src.shape[1:], dtype=src.dtype)
    return out.index_add_(0, seg, src)
def _pad(x, pw):
    flat = tuple(v for pair in reversed(pw) for v in pair)
    return torch.nn.functional.pad(x, flat)

kernel_name = 'gated_mix__sliding_block__dense_activation_gelu__prompt'

def setup_inputs():

    _w = (lambda a: (lambda t: t.to(torch.bfloat16) if t.is_floating_point() else t)(torch.as_tensor(a)))
    def _A_setup():
        B, S, D = 1, 2048, 448
        return {
            "x": _w((lambda *s: torch.randn(*s, dtype=torch.bfloat16) * 0.05)(B, S, D)),
            "wqkv": _w((lambda *s: torch.randn(*s, dtype=torch.bfloat16) * 0.8)(D, 3 * D)),
            "wo": _w((lambda *s: torch.randn(*s, dtype=torch.bfloat16) * 0.05)(D, D)),
        }
    _A_in = _A_setup()

    def _B_setup():
        B, S, D, F = 1, 2048, 448, 1792
        return {
            "x": _w((lambda *s: torch.randn(*s, dtype=torch.bfloat16) * 0.05)(B, S, D)),
            "w1": _w((lambda *s: torch.randn(*s, dtype=torch.bfloat16) * 12.8)(D, F) * (D ** -0.5)),
            "b1": _w((lambda *s: torch.randn(*s, dtype=torch.bfloat16) * 12.8)(F) * 0.01),
            "w2": _w((lambda *s: torch.randn(*s, dtype=torch.bfloat16) * 0.8)(F, D) * (F ** -0.5)),
            "b2": _w((lambda *s: torch.randn(*s, dtype=torch.bfloat16) * 6.4)(D) * 0.01),
        }
    _B_in = _B_setup()

    return {
        "A_x": _A_in["x"],
        "A_wqkv": _A_in["wqkv"],
        "A_wo": _A_in["wo"],
        "B_x": _B_in["x"],
        "B_w1": _B_in["w1"],
        "B_b1": _B_in["b1"],
        "B_w2": _B_in["w2"],
        "B_b2": _B_in["b2"],
        "gate_w": _w((lambda *s: torch.randn(*s, dtype=torch.bfloat16) * 0.05)(448) * 16.0),
    }

def reference(A_x, A_wqkv, A_wo, B_x, B_w1, B_b1, B_w2, B_b2, gate_w):
    def _A_ref(x, wqkv, wo):
        B, S, D = x.shape
        H = 16; Dh = D // H; W = 256
        qkv = (lambda x, *d: x.permute(*d))((x @ wqkv).reshape(B, S, 3, H, Dh), 2, 0, 3, 1, 4)
        q, k, v = qkv[0], qkv[1], qkv[2]
        scores = torch.einsum("bhqd,bhkd->bhqk", q, k) * (Dh ** -0.5)
        idx = torch.arange(S)
        mask = (idx[:, None] - idx[None, :] >= 0) & (idx[:, None] - idx[None, :] < W)
        scores = torch.where(mask[None, None], scores, -1e9)
        p = _softmax(scores, axis=-1)
        o = torch.einsum("bhqk,bhkd->bhqd", p, v)
        return (lambda x, *d: x.permute(*d))(o, 0, 2, 1, 3).reshape(B, S, D) @ wo

    def _B_ref(x, w1, b1, w2, b2):
        h = torch.einsum("bsd,df->bsf", x, w1) + b1
        h = _gelu(h)
        return torch.einsum("bsf,fd->bsd", h, w2) + b2

    x = A_x
    g = _sigmoid((x * gate_w).sum(-1, keepdims=True))
    a = _A_ref(x, A_wqkv, A_wo)
    b = _B_ref(x, B_w1, B_b1, B_w2, B_b2)
    return g * a + (1 - g) * b
```

```asm
; @launch grid=(256,1,1) block=(256,1,1) lds=163840
.amdgcn_target "amdgcn-amd-amdhsa--gfx950"
.text
.globl gated_mix__sliding_block__dense_activation_gelu__prompt_kernel
.p2align 8
.type gated_mix__sliding_block__dense_activation_gelu__prompt_kernel,@function
gated_mix__sliding_block__dense_activation_gelu__prompt_kernel:
    s_load_dwordx2 s[28:29], s[0:1], 0
    s_load_dwordx2 s[32:33], s[0:1], 8
    s_load_dwordx2 s[36:37], s[0:1], 32
    s_load_dwordx8 s[12:19], s[0:1], 40
    s_load_dwordx2 s[40:41], s[0:1], 88
    s_load_dwordx2 s[44:45], s[0:1], 72
    s_load_dwordx2 s[20:21], s[0:1], 16
    s_lshr_b32 s11, s2, 3
    s_cmpk_ge_u32 s2, 256
    s_cbranch_scc1 L_end
    s_getpc_b64 s[56:57]
    v_lshlrev_b32 v15, 7, v0
    v_min_u32 v15, 32256, v15
    global_load_dword v234, v15, s[56:57]
    v_lshrrev_b32 v5, 6, v0
    v_and_b32 v1, 63, v0
    v_readfirstlane_b32 s3, v5
    s_and_b32 s10, s2, 7
    s_lshr_b32 s8, s2, 6
    s_bfe_u32 s99, s2, 0x30003
    s_mov_b32 s31, 0x20000
    s_mov_b32 s30, 1835008
    s_cmp_eq_u32 s99, 7
    s_cbranch_scc1 L_prep
    s_add_u32 s7, s99, s8
    s_lshl_b32 s7, s7, 1
    s_lshr_b32 s7, 0x24924, s7
    s_and_b32 s7, s7, 3
    s_lshl_b32 s7, s7, 1
    s_and_b32 s52, s10, 3
    s_lshl2_add_u32 s52, s52, s8
    s_lshl2_add_u32 s54, s52, s3
    v_lshrrev_b32 v11, 3, v1
    v_and_b32 v12, 7, v1
    v_lshrrev_b32 v13, 4, v1
    s_lshl_b32 s58, s54, 5
    v_add_u32 v11, s58, v11
    v_mul_u32_u24 v11, 896, v11
    v_xor_b32 v12, v13, v12
    v_lshl_add_u32 v192, v12, 4, v11
    v_xor_b32 v193, 64, v192
    s_lshl_b32 s23, s3, 12
    v_add_u32 v194, 12288, v192
    v_add_u32 v195, 18432, v193
    v_add_u32 v193, 6144, v193
    s_lshl_b32 s4, s7, 7
    s_add_u32 m0, s23, 0
    s_waitcnt lgkmcnt(0)
    buffer_load_dwordx4 v192, s[28:31], s4 offen offset:0 lds
    buffer_load_dwordx4 v193, s[28:31], s4 offen offset:1024 lds
    buffer_load_dwordx4 v194, s[28:31], s4 offen offset:2048 lds
    buffer_load_dwordx4 v195, s[28:31], s4 offen offset:3072 lds
    s_mul_i32 s5, s7, 172032
    s_mov_b32 s22, s7
    s_lshr_b32 s53, s10, 2
    s_mul_i32 s53, s53, 7
    s_add_u32 s53, s53, s99
    s_mul_i32 s58, s3, 192
    s_mul_i32 s59, s53, 192
    v_add_u32 v11, s58, v1
    v_lshl_add_u32 v13, v11, 4, s59
    v_mul_u32_u24 v11, 0xaaab, v11
    s_movk_i32 s59, 2496
    v_lshrrev_b32 v12, 19, v11
    v_mad_u32_u24 v196, v12, s59, v13
    v_add_u32 v11, 2796224, v11
    v_lshrrev_b32 v12, 19, v11
    v_mad_u32_u24 v197, v12, s59, v13
    v_add_u32 v11, 2796224, v11
    v_lshrrev_b32 v12, 19, v11
    v_mad_u32_u24 v198, v12, s59, v13
    s_lshl_b32 s58, s58, 4
    s_movk_i32 s60, 16384
    s_add_u32 s24, s58, s60
    s_mov_b32 s34, 1204224
    s_mov_b32 s35, 0x20000
    s_add_u32 m0, s24, 0
    s_nop 0
    buffer_load_dwordx4 v196, s[32:35], s5 offen offset:0 lds
    buffer_load_dwordx4 v197, s[32:35], s5 offen offset:1024 lds
    buffer_load_dwordx4 v198, s[32:35], s5 offen offset:2048 lds
    s_load_dword s26, s[40:41], 0
    s_lshl_b32 s59, s53, 8
    v_lshl_add_u32 v11, v1, 2, s59
    global_load_dword v9, v11, s[12:13]
    s_lshl_b32 s59, s99, 7
    v_and_b32_e64 v11, 31, v1
    v_lshl_add_u32 v11, v11, 2, s59
    global_load_dword v235, v11, s[16:17]
    s_add_u32 s7, s7, 1
    s_cmp_eq_u32 s7, 7
    s_cselect_b32 s7, 0, s7
    s_lshl_b32 s4, s7, 7
    s_add_u32 m0, s23, 28672
    s_mul_i32 s5, s7, 172032
    buffer_load_dwordx4 v192, s[28:31], s4 offen offset:0 lds
    buffer_load_dwordx4 v193, s[28:31], s4 offen offset:1024 lds
    buffer_load_dwordx4 v194, s[28:31], s4 offen offset:2048 lds
    buffer_load_dwordx4 v195, s[28:31], s4 offen offset:3072 lds
    s_add_u32 m0, s24, 28672
    s_nop 0
    buffer_load_dwordx4 v196, s[32:35], s5 offen offset:0 lds
    buffer_load_dwordx4 v197, s[32:35], s5 offen offset:1024 lds
    buffer_load_dwordx4 v198, s[32:35], s5 offen offset:2048 lds
    v_and_b32 v11, 31, v1
    v_lshrrev_b32 v12, 5, v1
    v_bfe_u32 v13, v1, 1, 3
    v_xor_b32 v13, v13, v12
    v_lshl_add_u32 v11, v11, 7, s23
    v_xor_b32 v14, 0, v13
    v_lshl_add_u32 v203, v14, 4, v11
    v_xor_b32 v14, 2, v13
    v_lshl_add_u32 v204, v14, 4, v11
    v_xor_b32 v14, 4, v13
    v_lshl_add_u32 v205, v14, 4, v11
    v_xor_b32 v14, 6, v13
    v_lshl_add_u32 v206, v14, 4, v11
    v_bfe_u32 v11, v1, 2, 2
    v_lshl_add_u32 v12, v12, 3, v11
    v_bfe_u32 v13, v1, 4, 1
    v_lshlrev_b32 v13, 5, v13
    v_and_b32 v14, 3, v1
    v_lshl_add_u32 v13, v14, 3, v13
    v_mul_u32_u24 v207, 192, v12
    v_add3_u32 v207, v207, v13, s60
    v_bfe_u32 v14, 6, v14, 1
    v_mul_u32_u24 v14, 24, v14
    v_xor_b32 v207, v207, v14
    v_add_u32 v213, 57344, v207
    v_lshl_add_u32 v13, v12, 8, v13
    v_add_u32 v13, 98304, v13
    v_xor_b32 v14, 0, v11
    v_lshl_add_u32 v208, v14, 6, v13
    v_xor_b32 v14, 1, v11
    v_lshl_add_u32 v209, v14, 6, v13
    v_xor_b32 v14, 2, v11
    v_lshl_add_u32 v210, v14, 6, v13
    v_xor_b32 v14, 3, v11
    v_lshl_add_u32 v211, v14, 6, v13
    s_add_u32 s7, s7, 1
    s_cmp_eq_u32 s7, 7
    s_cselect_b32 s7, 0, s7
    s_lshl_b32 s4, s7, 7
    s_add_u32 m0, s23, 57344
    s_mul_i32 s5, s7, 172032
    buffer_load_dwordx4 v192, s[28:31], s4 offen offset:0 lds
    buffer_load_dwordx4 v193, s[28:31], s4 offen offset:1024 lds
    buffer_load_dwordx4 v194, s[28:31], s4 offen offset:2048 lds
    buffer_load_dwordx4 v195, s[28:31], s4 offen offset:3072 lds
    s_add_u32 m0, s24, 57344
    s_nop 0
    buffer_load_dwordx4 v196, s[32:35], s5 offen offset:0 lds
    buffer_load_dwordx4 v197, s[32:35], s5 offen offset:1024 lds
    buffer_load_dwordx4 v198, s[32:35], s5 offen offset:2048 lds
    s_waitcnt vmcnt(16)
    s_waitcnt lgkmcnt(0)
    s_barrier
    ds_read_b128 a[0:3], v203 offset:0
    ds_read_b64_tr_b16 v[128:129], v207 offset:0
    ds_read_b64_tr_b16 v[130:131], v207 offset:768
    ds_read_b64_tr_b16 v[132:133], v207 offset:64
    ds_read_b64_tr_b16 v[134:135], v207 offset:832
    ds_read_b64_tr_b16 v[136:137], v207 offset:128
    ds_read_b64_tr_b16 v[138:139], v207 offset:896
    s_waitcnt lgkmcnt(4)
    v_mfma_f32_32x32x16_bf16 v[16:31], v[128:131], a[0:3], 0
    ds_read_b128 a[4:7], v204 offset:0
    ds_read_b64_tr_b16 v[144:145], v207 offset:3072
    ds_read_b64_tr_b16 v[146:147], v207 offset:3840
    v_lshrrev_b32 v13, 4, v1
    v_lshlrev_b32 v12, 2, v13
    v_xor_b32 v12, v12, v1
    v_and_b32 v12, 15, v12
    s_waitcnt lgkmcnt(5)
    v_mfma_f32_32x32x16_bf16 v[32:47], v[132:135], a[0:3], 0
    ds_read_b64_tr_b16 v[148:149], v207 offset:3136
    ds_read_b64_tr_b16 v[150:151], v207 offset:3904
    s_lshl_b32 s58, s3, 4
    v_add_u32 v11, s58, v13
    v_mul_u32_u24 v11, 3584, v11
    s_waitcnt lgkmcnt(5)
    v_mfma_f32_32x32x16_bf16 v[48:63], v[136:139], a[0:3], 0
    ds_read_b64_tr_b16 v[152:153], v207 offset:3200
    ds_read_b64_tr_b16 v[154:155], v207 offset:3968
    s_lshl_b32 s59, s53, 8
    v_lshl_add_u32 v11, v12, 4, v11
    v_add_u32 v199, s59, v11
    v_add_u32 v200, 13312, v199
    s_waitcnt lgkmcnt(4)
    v_mfma_f32_32x32x16_bf16 v[16:31], v[144:147], a[4:7], v[16:31]
    ds_read_b128 a[8:11], v205 offset:0
    ds_read_b64_tr_b16 v[128:129], v207 offset:6144
    ds_read_b64_tr_b16 v[130:131], v207 offset:6912
    v_add_u32 v201, 26624, v199
    v_add_u32 v202, 39936, v199
    s_mov_b32 s38, 1605632
    s_waitcnt lgkmcnt(5)
    v_mfma_f32_32x32x16_bf16 v[32:47], v[148:151], a[4:7], v[32:47]
    ds_read_b64_tr_b16 v[132:133], v207 offset:6208
    ds_read_b64_tr_b16 v[134:135], v207 offset:6976
    s_mov_b32 s39, 0x20000
    v_lshlrev_b32 v2, 4, v1
    v_cmp_eq_u32 vcc, 0, v1
    v_mov_b32 v5, 0x7fff0000
    v_add_u32 v3, 0x1000, v2
    v_cndmask_b32_e64 v4, v5, 0, vcc
    s_waitcnt lgkmcnt(5)
    v_mfma_f32_32x32x16_bf16 v[48:63], v[152:155], a[4:7], v[48:63]
    ds_read_b64_tr_b16 v[136:137], v207 offset:6272
    ds_read_b64_tr_b16 v[138:139], v207 offset:7040
    s_lshl2_add_u32 s98, s10, s8
    s_waitcnt lgkmcnt(4)
    v_mfma_f32_32x32x16_bf16 v[16:31], v[128:131], a[8:11], v[16:31]
    ds_read_b128 a[12:15], v206 offset:0
    ds_read_b64_tr_b16 v[144:145], v207 offset:9216
    ds_read_b64_tr_b16 v[146:147], v207 offset:9984
    ds_read_b64_tr_b16 v[148:149], v207 offset:9280
    s_mov_b32 s42, 16777216
    s_mov_b32 s43, 0x20000
    s_mov_b32 s46, 1835008
    s_waitcnt lgkmcnt(6)
    v_mfma_f32_32x32x16_bf16 v[32:47], v[132:135], a[8:11], v[32:47]
    s_nop 0
    ds_read_b64_tr_b16 v[150:151], v207 offset:10048
    ds_read_b64_tr_b16 v[152:153], v207 offset:9344
    ds_read_b64_tr_b16 v[154:155], v207 offset:10112
    s_mov_b32 s47, 0x20000
    v_mov_b32 v212, 0xbdd2d3e8
    v_mov_b32 v214, 0xc0135761
    s_waitcnt lgkmcnt(7)
    v_mfma_f32_32x32x16_bf16 v[48:63], v[136:139], a[8:11], v[48:63]
    v_lshlrev_b32 v215, 7, v1
    s_mul_i32 s61, s54, 87040
    s_mul_i32 s56, s53, 6144
    s_add_u32 s61, s61, s56
    s_waitcnt lgkmcnt(0)
    s_waitcnt vmcnt(7)
    s_barrier
    v_mfma_f32_32x32x16_bf16 v[16:31], v[144:147], a[12:15], v[16:31]
    ds_read_b128 a[16:19], v203 offset:28672
    ds_read_b64_tr_b16 v[128:129], v207 offset:28672
    ds_read_b64_tr_b16 v[130:131], v207 offset:29440
    s_add_u32 s7, s7, 1
    s_cmp_eq_u32 s7, 7
    s_cselect_b32 s7, 0, s7
    s_lshl_b32 s4, s7, 7
    s_add_u32 m0, s23, 0
    s_mul_i32 s5, s7, 172032
    buffer_load_dwordx4 v192, s[28:31], s4 offen offset:0 lds
    s_add_u32 s61, s61, 1048576
    s_mul_i32 s62, s54, 148480
    s_lshl_b32 s56, s53, 13
    v_mfma_f32_32x32x16_bf16 v[32:47], v[148:151], a[12:15], v[32:47]
    ds_read_b64_tr_b16 v[132:133], v207 offset:28736
    ds_read_b64_tr_b16 v[134:135], v207 offset:29504
    buffer_load_dwordx4 v193, s[28:31], s4 offen offset:1024 lds
    s_add_u32 s62, s62, s56
    s_add_u32 s62, s62, 6815744
    s_lshl4_add_u32 s56, s54, s53
    v_mfma_f32_32x32x16_bf16 v[48:63], v[152:155], a[12:15], v[48:63]
    ds_read_b64_tr_b16 v[136:137], v207 offset:28800
    ds_read_b64_tr_b16 v[138:139], v207 offset:29568
    s_lshl_b32 s56, s56, 7
    s_add_u32 s12, s56, 131072
    s_add_u32 s13, s56, 262144
    s_mul_i32 s19, s53, 3
    s_waitcnt lgkmcnt(4)
    v_mfma_f32_32x32x16_bf16 v[16:31], v[128:131], a[16:19], v[16:31]
    ds_read_b128 a[20:23], v204 offset:28672
    ds_read_b64_tr_b16 v[144:145], v207 offset:31744
    ds_read_b64_tr_b16 v[146:147], v207 offset:32512
    buffer_load_dwordx4 v194, s[28:31], s4 offen offset:2048 lds
    s_mov_b32 s9, 0
    s_mov_b64 s[48:49], s[14:15]
    s_mov_b32 s50, 1605632
    s_waitcnt lgkmcnt(5)
    v_mfma_f32_32x32x16_bf16 v[32:47], v[132:135], a[16:19], v[32:47]
    ds_read_b64_tr_b16 v[148:149], v207 offset:31808
    ds_read_b64_tr_b16 v[150:151], v207 offset:32576
    s_mov_b32 s51, 0x20000
    s_mul_i32 s55, s3, 401408
    s_lshl_b32 s59, s99, 7
    s_add_u32 s55, s55, s59
    s_waitcnt lgkmcnt(5)
    v_mfma_f32_32x32x16_bf16 v[48:63], v[136:139], a[16:19], v[48:63]
    ds_read_b64_tr_b16 v[152:153], v207 offset:31872
    ds_read_b64_tr_b16 v[154:155], v207 offset:32640
    buffer_load_dwordx4 v195, s[28:31], s4 offen offset:3072 lds
    v_lshrrev_b32 v11, 3, v1
    v_bfe_u32 v12, v1, 4, 1
    v_lshlrev_b32 v12, 2, v12
    s_waitcnt lgkmcnt(4)
    v_mfma_f32_32x32x16_bf16 v[16:31], v[144:147], a[20:23], v[16:31]
    ds_read_b128 a[24:27], v205 offset:28672
    ds_read_b64_tr_b16 v[128:129], v207 offset:34816
    ds_read_b64_tr_b16 v[130:131], v207 offset:35584
    s_add_u32 m0, s24, 0
    s_nop 0
    buffer_load_dwordx4 v196, s[32:35], s5 offen offset:0 lds
    v_xor_b32 v12, v12, v1
    v_and_b32_e64 v12, 7, v12
    v_mul_u32_u24 v11, 896, v11
    s_waitcnt lgkmcnt(5)
    v_mfma_f32_32x32x16_bf16 v[32:47], v[148:151], a[20:23], v[32:47]
    ds_read_b64_tr_b16 v[132:133], v207 offset:34880
    ds_read_b64_tr_b16 v[134:135], v207 offset:35648
    v_lshl_add_u32 v216, v12, 4, v11
    v_add_u32 v217, 6144, v216
    v_add_u32 v218, 12288, v216
    v_add_u32 v219, 18432, v216
    s_waitcnt lgkmcnt(5)
    v_mfma_f32_32x32x16_bf16 v[48:63], v[152:155], a[20:23], v[48:63]
    ds_read_b64_tr_b16 v[136:137], v207 offset:34944
    ds_read_b64_tr_b16 v[138:139], v207 offset:35712
    buffer_load_dwordx4 v197, s[32:35], s5 offen offset:1024 lds
    v_bfe_u32 v11, v1, 2, 2
    v_lshrrev_b32 v12, 5, v1
    v_lshl_add_u32 v12, v12, 2, v11
    s_waitcnt lgkmcnt(4)
    v_mfma_f32_32x32x16_bf16 v[16:31], v[128:131], a[24:27], v[16:31]
    ds_read_b128 a[28:31], v206 offset:28672
    ds_read_b64_tr_b16 v[144:145], v207 offset:37888
    ds_read_b64_tr_b16 v[146:147], v207 offset:38656
    ds_read_b64_tr_b16 v[148:149], v207 offset:37952
    v_lshlrev_b32 v12, 7, v12
    v_bfe_u32 v13, v1, 4, 1
    v_lshl_add_u32 v12, v13, 5, v12
    s_waitcnt lgkmcnt(6)
    v_mfma_f32_32x32x16_bf16 v[32:47], v[132:135], a[24:27], v[32:47]
    ds_read_b64_tr_b16 v[150:151], v207 offset:38720
    ds_read_b64_tr_b16 v[152:153], v207 offset:38016
    ds_read_b64_tr_b16 v[154:155], v207 offset:38784
    buffer_load_dwordx4 v198, s[32:35], s5 offen offset:2048 lds
    v_and_b32 v13, 3, v1
    v_lshl_add_u32 v12, v13, 3, v12
    v_lshrrev_b32 v11, 1, v11
    v_lshl_add_u32 v11, v11, 6, v12
    s_waitcnt lgkmcnt(7)
    v_mfma_f32_32x32x16_bf16 v[48:63], v[136:139], a[24:27], v[48:63]
    v_add_u32 v11, s23, v11
    v_bfe_u32 v12, 6, v13, 1
    v_mul_u32_u24 v12, 24, v12
    s_waitcnt lgkmcnt(0)
    s_waitcnt vmcnt(7)
    s_barrier
    v_mfma_f32_32x32x16_bf16 v[16:31], v[144:147], a[28:31], v[16:31]
    ds_read_b128 a[32:35], v203 offset:57344
    ds_read_b64_tr_b16 v[128:129], v213 offset:0
    ds_read_b64_tr_b16 v[130:131], v213 offset:768
    s_add_u32 s7, s7, 1
    s_cmp_eq_u32 s7, 7
    s_cselect_b32 s7, 0, s7
    s_lshl_b32 s4, s7, 7
    s_add_u32 m0, s23, 28672
    s_mul_i32 s5, s7, 172032
    buffer_load_dwordx4 v192, s[28:31], s4 offen offset:0 lds
    v_xor_b32 v11, v11, v12
    s_lshr_b32 s56, s3, 1
    s_lshl_b32 s56, s56, 6
    v_mfma_f32_32x32x16_bf16 v[32:47], v[148:151], a[28:31], v[32:47]
    ds_read_b64_tr_b16 v[132:133], v213 offset:64
    ds_read_b64_tr_b16 v[134:135], v213 offset:832
    buffer_load_dwordx4 v193, s[28:31], s4 offen offset:1024 lds
    v_xor_b32 v233, s56, v11
    v_xor_b32 v232, 64, v233
    v_add_u32 v0, 0x10000, v232
    v_add_u32 v230, 0x10000, v233
    v_mfma_f32_32x32x16_bf16 v[48:63], v[152:155], a[28:31], v[48:63]
    ds_read_b64_tr_b16 v[136:137], v213 offset:128
    ds_read_b64_tr_b16 v[138:139], v213 offset:896
    s_and_b32 s14, s11, 15
    s_lshr_b32 s100, s11, 4
    s_lshl1_add_u32 s100, s10, s100
    s_waitcnt lgkmcnt(4)
    v_mfma_f32_32x32x16_bf16 v[16:31], v[128:131], a[32:35], v[16:31]
    ds_read_b128 a[36:39], v204 offset:57344
    ds_read_b64_tr_b16 v[144:145], v213 offset:3072
    ds_read_b64_tr_b16 v[146:147], v213 offset:3840
    buffer_load_dwordx4 v194, s[28:31], s4 offen offset:2048 lds
    s_lshl2_add_u32 s15, s14, s3
    s_and_b32 s101, s100, 1
    s_lshl4_add_u32 s56, s15, s100
    s_lshl_b32 s56, s56, 7
    s_waitcnt lgkmcnt(5)
    v_mfma_f32_32x32x16_bf16 v[32:47], v[132:135], a[32:35], v[32:47]
    ds_read_b64_tr_b16 v[148:149], v213 offset:3136
    ds_read_b64_tr_b16 v[150:151], v213 offset:3904
    s_add_u32 s25, s56, 393216
    s_mul_i32 s58, s15, 148480
    s_lshl_b32 s59, s100, 11
    s_waitcnt lgkmcnt(5)
    v_mfma_f32_32x32x16_bf16 v[48:63], v[136:139], a[32:35], v[48:63]
    ds_read_b64_tr_b16 v[152:153], v213 offset:3200
    ds_read_b64_tr_b16 v[154:155], v213 offset:3968
    buffer_load_dwordx4 v195, s[28:31], s4 offen offset:3072 lds
    s_add_u32 s58, s58, s59
    s_add_u32 s18, s58, 6930432
    v_min_u32 v11, 13, v1
    s_waitcnt lgkmcnt(4)
    v_mfma_f32_32x32x16_bf16 v[16:31], v[144:147], a[36:39], v[16:31]
    ds_read_b128 a[40:43], v205 offset:57344
    ds_read_b64_tr_b16 v[128:129], v213 offset:6144
    ds_read_b64_tr_b16 v[130:131], v213 offset:6912
    s_add_u32 m0, s24, 28672
    s_nop 0
    buffer_load_dwordx4 v196, s[32:35], s5 offen offset:0 lds
    v_lshrrev_b32 v12, 1, v11
    v_and_b32 v11, 1, v11
    s_mul_i32 s56, s100, 7
    s_lshr_b32 s56, s56, 1
    s_waitcnt lgkmcnt(5)
    v_mfma_f32_32x32x16_bf16 v[32:47], v[148:151], a[36:39], v[32:47]
    ds_read_b64_tr_b16 v[132:133], v213 offset:6208
    ds_read_b64_tr_b16 v[134:135], v213 offset:6976
    s_lshl_b32 s56, s56, 3
    v_mad_u32_u24 v11, v11, 31, s56
    v_mov_b32 v13, 896
    s_waitcnt lgkmcnt(5)
    v_mfma_f32_32x32x16_bf16 v[48:63], v[152:155], a[36:39], v[48:63]
    ds_read_b64_tr_b16 v[136:137], v213 offset:6272
    ds_read_b64_tr_b16 v[138:139], v213 offset:7040
    buffer_load_dwordx4 v197, s[32:35], s5 offen offset:1024 lds
    v_mov_b32 v14, 448
    v_subrev_u32 v15, 3, v12
    v_cmp_gt_u32 vcc, 3, v12
    s_nop 1
    v_cndmask_b32 v13, v13, v14, vcc
    v_cndmask_b32 v14, v15, v12, vcc
    s_waitcnt lgkmcnt(4)
    v_mfma_f32_32x32x16_bf16 v[16:31], v[128:131], a[40:43], v[16:31]
    ds_read_b128 a[44:47], v206 offset:57344
    ds_read_b64_tr_b16 v[144:145], v213 offset:9216
    ds_read_b64_tr_b16 v[146:147], v213 offset:9984
    ds_read_b64_tr_b16 v[148:149], v213 offset:9280
    s_mul_i32 s57, s3, 3
    s_lshl2_add_u32 s57, s14, s57
    s_waitcnt lgkmcnt(6)
    v_mfma_f32_32x32x16_bf16 v[32:47], v[132:135], a[40:43], v[32:47]
    ds_read_b64_tr_b16 v[150:151], v213 offset:10048
    ds_read_b64_tr_b16 v[152:153], v213 offset:9344
    ds_read_b64_tr_b16 v[154:155], v213 offset:10112
    buffer_load_dwordx4 v198, s[32:35], s5 offen offset:2048 lds
    s_sub_u32 s57, s57, 8
    v_add_u32 v14, s57, v14
    v_max_i32 v14, 0, v14
    s_waitcnt lgkmcnt(7)
    v_mfma_f32_32x32x16_bf16 v[48:63], v[136:139], a[40:43], v[48:63]
    v_mov_b32 v15, s15
    v_cmp_eq_u32 vcc, 6, v12
    s_nop 1
    v_cndmask_b32_e64 v13, v13, 0, vcc
    v_cndmask_b32 v14, v14, v15, vcc
    s_waitcnt lgkmcnt(0)
    s_waitcnt vmcnt(7)
    s_barrier
    v_mfma_f32_32x32x16_bf16 v[16:31], v[144:147], a[44:47], v[16:31]
    ds_read_b128 a[48:51], v203 offset:0
    ds_read_b64_tr_b16 v[128:129], v207 offset:0
    ds_read_b64_tr_b16 v[130:131], v207 offset:768
    s_add_u32 s7, s7, 1
    s_cmp_eq_u32 s7, 7
    s_cselect_b32 s7, 0, s7
    s_lshl_b32 s4, s7, 7
    s_add_u32 m0, s23, 57344
    s_mul_i32 s5, s7, 172032
    buffer_load_dwordx4 v192, s[28:31], s4 offen offset:0 lds
    v_add_u32 v11, v11, v13
    v_mul_u32_u24 v11, 683, v11
    v_lshrrev_b32 v11, 16, v11
    v_mfma_f32_32x32x16_bf16 v[32:47], v[148:151], a[44:47], v[32:47]
    ds_read_b64_tr_b16 v[132:133], v207 offset:64
    ds_read_b64_tr_b16 v[134:135], v207 offset:832
    buffer_load_dwordx4 v193, s[28:31], s4 offen offset:1024 lds
    v_lshl_add_u32 v11, v14, 4, v11
    v_lshlrev_b32 v11, 7, v11
    v_add_u32 v10, 131072, v11
    v_mfma_f32_32x32x16_bf16 v[48:63], v[152:155], a[44:47], v[48:63]
    ds_read_b64_tr_b16 v[136:137], v207 offset:128
    ds_read_b64_tr_b16 v[138:139], v207 offset:896
    s_lshr_b32 s56, s15, 1
    s_lshl_b32 s56, s56, 7
    s_add_u32 s56, s56, 4096
    s_waitcnt lgkmcnt(4)
    v_mfma_f32_32x32x16_bf16 v[16:31], v[128:131], a[48:51], v[16:31]
    ds_read_b128 a[52:55], v204 offset:0
    ds_read_b64_tr_b16 v[144:145], v207 offset:3072
    ds_read_b64_tr_b16 v[146:147], v207 offset:3840
    buffer_load_dwordx4 v194, s[28:31], s4 offen offset:2048 lds
    s_lshl_b32 s57, s98, 7
    s_add_u32 s57, s57, 4096
    v_writelane_b32 v10, s56, 14
    v_writelane_b32 v10, s57, 15
    s_waitcnt lgkmcnt(5)
    v_mfma_f32_32x32x16_bf16 v[32:47], v[132:135], a[48:51], v[32:47]
    ds_read_b64_tr_b16 v[148:149], v207 offset:3136
    ds_read_b64_tr_b16 v[150:151], v207 offset:3904
    s_mul_i32 s56, s100, 7
    s_lshr_b32 s56, s56, 1
    s_lshl_b32 s63, s56, 9
    s_waitcnt lgkmcnt(5)
    v_mfma_f32_32x32x16_bf16 v[48:63], v[136:139], a[48:51], v[48:63]
    ds_read_b64_tr_b16 v[152:153], v207 offset:3200
    ds_read_b64_tr_b16 v[154:155], v207 offset:3968
    buffer_load_dwordx4 v195, s[28:31], s4 offen offset:3072 lds
    s_add_u32 s57, s63, 28672
    v_add_u32 v247, s57, v2
    v_lshrrev_b32 v11, 5, v1
    v_and_b32 v12, 31, v1
    s_waitcnt lgkmcnt(4)
    v_mfma_f32_32x32x16_bf16 v[16:31], v[144:147], a[52:55], v[16:31]
    ds_read_b128 a[56:59], v205 offset:0
    ds_read_b64_tr_b16 v[128:129], v207 offset:6144
    ds_read_b64_tr_b16 v[130:131], v207 offset:6912
    s_add_u32 m0, s24, 57344
    s_nop 0
    buffer_load_dwordx4 v196, s[32:35], s5 offen offset:0 lds
    s_add_u32 s57, s63, 55296
    v_lshlrev_b32 v13, 2, v11
    v_xor_b32 v13, v13, v12
    s_waitcnt lgkmcnt(5)
    v_mfma_f32_32x32x16_bf16 v[32:47], v[148:151], a[52:55], v[32:47]
    ds_read_b64_tr_b16 v[132:133], v207 offset:6208
    ds_read_b64_tr_b16 v[134:135], v207 offset:6976
    v_lshlrev_b32 v13, 4, v13
    v_lshl_add_u32 v13, v11, 9, v13
    v_add_u32 v248, s57, v13
    s_waitcnt lgkmcnt(5)
    v_mfma_f32_32x32x16_bf16 v[48:63], v[152:155], a[52:55], v[48:63]
    ds_read_b64_tr_b16 v[136:137], v207 offset:6272
    ds_read_b64_tr_b16 v[138:139], v207 offset:7040
    buffer_load_dwordx4 v197, s[32:35], s5 offen offset:1024 lds
    v_xor_b32 v249, 128, v248
    v_add_u32 v244, s23, v2
    v_bfe_u32 v12, v1, 4, 1
    v_bfe_u32 v13, v1, 1, 1
    s_waitcnt lgkmcnt(4)
    v_mfma_f32_32x32x16_bf16 v[16:31], v[128:131], a[56:59], v[16:31]
    ds_read_b128 a[60:63], v206 offset:0
    ds_read_b64_tr_b16 v[144:145], v207 offset:9216
    ds_read_b64_tr_b16 v[146:147], v207 offset:9984
    ds_read_b64_tr_b16 v[148:149], v207 offset:9280
    v_lshl_add_u32 v14, v12, 1, v13
    v_lshlrev_b32 v15, 9, v14
    v_xor_b32 v14, v14, v11
    s_waitcnt lgkmcnt(6)
    v_mfma_f32_32x32x16_bf16 v[32:47], v[132:135], a[56:59], v[32:47]
    ds_read_b64_tr_b16 v[150:151], v207 offset:10048
    ds_read_b64_tr_b16 v[152:153], v207 offset:9344
    ds_read_b64_tr_b16 v[154:155], v207 offset:10112
    buffer_load_dwordx4 v198, s[32:35], s5 offen offset:2048 lds
    v_lshl_add_u32 v15, v14, 6, v15
    v_bfe_u32 v14, v1, 2, 2
    v_lshl_add_u32 v15, v14, 4, v15
    s_waitcnt lgkmcnt(7)
    v_mfma_f32_32x32x16_bf16 v[48:63], v[136:139], a[56:59], v[48:63]
    v_and_b32 v14, 1, v1
    v_lshl_add_u32 v15, v14, 3, v15
    s_add_u32 s57, s23, 2048
    v_add_u32 v245, s57, v15
    s_waitcnt lgkmcnt(0)
    s_waitcnt vmcnt(7)
    s_barrier
    v_mfma_f32_32x32x16_bf16 v[16:31], v[144:147], a[60:63], v[16:31]
    ds_read_b128 a[64:67], v203 offset:28672
    ds_read_b64_tr_b16 v[128:129], v207 offset:28672
    ds_read_b64_tr_b16 v[130:131], v207 offset:29440
    s_add_u32 s7, s7, 1
    s_cmp_eq_u32 s7, 7
    s_cselect_b32 s7, 0, s7
    s_lshl_b32 s4, s7, 7
    s_add_u32 m0, s23, 0
    s_mul_i32 s5, s7, 172032
    buffer_load_dwordx4 v192, s[28:31], s4 offen offset:0 lds
    v_xor_b32 v246, 128, v245
    v_and_b32 v12, 31, v1
    v_mul_u32_u24 v13, 12, v11
    v_mfma_f32_32x32x16_bf16 v[32:47], v[148:151], a[60:63], v[32:47]
    ds_read_b64_tr_b16 v[132:133], v207 offset:28736
    ds_read_b64_tr_b16 v[134:135], v207 offset:29504
    buffer_load_dwordx4 v193, s[28:31], s4 offen offset:1024 lds
    s_cmp_eq_u32 s101, 0
    s_cselect_b32 s57, -1, 0
    s_cselect_b32 s58, 1544, 0
    v_mfma_f32_32x32x16_bf16 v[48:63], v[152:155], a[60:63], v[48:63]
    ds_read_b64_tr_b16 v[136:137], v207 offset:28800
    ds_read_b64_tr_b16 v[138:139], v207 offset:29568
    v_and_b32 v13, s57, v13
    v_xor_b32 v12, v12, v13
    v_lshlrev_b32 v12, 4, v12
    v_lshl_add_u32 v12, v11, 11, v12
    s_waitcnt lgkmcnt(4)
    v_mfma_f32_32x32x16_bf16 v[16:31], v[128:131], a[64:67], v[16:31]
    ds_read_b128 a[68:71], v204 offset:28672
    ds_read_b64_tr_b16 v[144:145], v207 offset:31744
    ds_read_b64_tr_b16 v[146:147], v207 offset:32512
    buffer_load_dwordx4 v194, s[28:31], s4 offen offset:2048 lds
    s_mul_i32 s59, s3, 12288
    s_add_u32 s58, s58, s59
    v_add_u32 v250, s58, v12
    s_waitcnt lgkmcnt(5)
    v_mfma_f32_32x32x16_bf16 v[32:47], v[132:135], a[64:67], v[32:47]
    ds_read_b64_tr_b16 v[148:149], v207 offset:31808
    ds_read_b64_tr_b16 v[150:151], v207 offset:32576
    s_mul_i32 s57, s3, 3
    s_lshl2_add_u32 s57, s14, s57
    v_mov_b32 v12, 0x3f80
    s_add_u32 s58, s57, 0
    s_waitcnt lgkmcnt(5)
    v_mfma_f32_32x32x16_bf16 v[48:63], v[136:139], a[64:67], v[48:63]
    ds_read_b64_tr_b16 v[152:153], v207 offset:31872
    ds_read_b64_tr_b16 v[154:155], v207 offset:32640
    buffer_load_dwordx4 v195, s[28:31], s4 offen offset:3072 lds
    s_cmp_lt_u32 s58, 8
    s_cselect_b32 s58, 0xf14a, 0
    v_mov_b32 v251, s58
    s_waitcnt lgkmcnt(4)
    v_mfma_f32_32x32x16_bf16 v[16:31], v[144:147], a[68:71], v[16:31]
    ds_read_b128 a[72:75], v205 offset:28672
    ds_read_b64_tr_b16 v[128:129], v207 offset:34816
    ds_read_b64_tr_b16 v[130:131], v207 offset:35584
    s_add_u32 m0, s24, 0
    s_nop 0
    buffer_load_dwordx4 v196, s[32:35], s5 offen offset:0 lds
    s_add_u32 s58, s57, 1
    s_cmp_lt_u32 s58, 8
    s_cselect_b32 s58, 0xf14a, 0
    s_waitcnt lgkmcnt(5)
    v_mfma_f32_32x32x16_bf16 v[32:47], v[148:151], a[68:71], v[32:47]
    ds_read_b64_tr_b16 v[132:133], v207 offset:34880
    ds_read_b64_tr_b16 v[134:135], v207 offset:35648
    v_mov_b32 v252, s58
    s_add_u32 s58, s57, 2
    s_cmp_lt_u32 s58, 8
    s_cselect_b32 s58, 0xf14a, 0
    s_waitcnt lgkmcnt(5)
    v_mfma_f32_32x32x16_bf16 v[48:63], v[152:155], a[68:71], v[48:63]
    ds_read_b64_tr_b16 v[136:137], v207 offset:34944
    ds_read_b64_tr_b16 v[138:139], v207 offset:35712
    buffer_load_dwordx4 v197, s[32:35], s5 offen offset:1024 lds
    v_mov_b32 v253, s58
    v_cmp_gt_u32 vcc, 32, v1
    s_nop 1
    v_cndmask_b32 v251, v12, v251, vcc
    v_cndmask_b32 v252, v12, v252, vcc
    v_cndmask_b32 v253, v12, v253, vcc
    s_waitcnt lgkmcnt(4)
    v_mfma_f32_32x32x16_bf16 v[16:31], v[128:131], a[72:75], v[16:31]
    ds_read_b128 a[76:79], v206 offset:28672
    ds_read_b64_tr_b16 v[144:145], v207 offset:37888
    ds_read_b64_tr_b16 v[146:147], v207 offset:38656
    ds_read_b64_tr_b16 v[148:149], v207 offset:37952
    s_lshl_b32 s56, s3, 9
    s_waitcnt lgkmcnt(6)
    v_mfma_f32_32x32x16_bf16 v[32:47], v[132:135], a[72:75], v[32:47]
    ds_read_b64_tr_b16 v[150:151], v207 offset:38720
    ds_read_b64_tr_b16 v[152:153], v207 offset:38016
    ds_read_b64_tr_b16 v[154:155], v207 offset:38784
    buffer_load_dwordx4 v198, s[32:35], s5 offen offset:2048 lds
    s_add_u32 s56, s56, 86016
    v_lshlrev_b32 v12, 16, v9
    v_and_b32 v13, 0xffff0000, v9
    v_lshl_add_u32 v14, v1, 3, s56
    s_waitcnt lgkmcnt(7)
    v_mfma_f32_32x32x16_bf16 v[48:63], v[136:139], a[72:75], v[48:63]
    ds_write_b64 v14, v[12:13]
    v_lshrrev_b32 v8, 5, v1
    v_lshl_add_u32 v8, v8, 4, s56
    s_waitcnt lgkmcnt(0)
    s_waitcnt vmcnt(7)
    s_barrier
    v_mfma_f32_32x32x16_bf16 v[16:31], v[144:147], a[76:79], v[16:31]
    s_nop 0
    ds_read_b128 a[80:83], v203 offset:57344
    ds_read_b64_tr_b16 v[128:129], v213 offset:0
    ds_read_b64_tr_b16 v[130:131], v213 offset:768
    s_add_u32 m0, s23, 114688
    s_mul_i32 s6, s22, 229376
    buffer_load_dwordx4 v199, s[36:39], s6 offen offset:0 lds
    v_lshrrev_b32_e64 v12, 5, v1
    v_mul_u32_u24 v12, 36, v12
    v_sub_u32 v12, v1, v12
    v_mfma_f32_32x32x16_bf16 v[32:47], v[148:151], a[76:79], v[32:47]
    ds_read_b64_tr_b16 v[132:133], v213 offset:64
    ds_read_b64_tr_b16 v[134:135], v213 offset:832
    buffer_load_dwordx4 v200, s[36:39], s6 offen offset:1024 lds
    v_cmp_le_i32_e64 s[64:65], 0, v12
    v_cmp_le_i32_e64 s[66:67], 1, v12
    v_cmp_le_i32_e64 s[68:69], 2, v12
    v_cmp_le_i32_e64 s[70:71], 3, v12
    v_mfma_f32_32x32x16_bf16 v[48:63], v[152:155], a[76:79], v[48:63]
    ds_read_b64_tr_b16 v[136:137], v213 offset:128
    ds_read_b64_tr_b16 v[138:139], v213 offset:896
    v_cmp_le_i32_e64 s[72:73], 8, v12
    v_cmp_le_i32_e64 s[74:75], 9, v12
    v_cmp_le_i32_e64 s[76:77], 10, v12
    s_waitcnt lgkmcnt(4)
    v_mfma_f32_32x32x16_bf16 v[16:31], v[128:131], a[80:83], v[16:31]
    s_nop 0
    ds_read_b128 a[84:87], v204 offset:57344
    ds_read_b64_tr_b16 v[144:145], v213 offset:3072
    ds_read_b64_tr_b16 v[146:147], v213 offset:3840
    ds_read_b128 v[64:67], v8 offset:0
    buffer_load_dwordx4 v201, s[36:39], s6 offen offset:2048 lds
    v_cmp_le_i32_e64 s[78:79], 11, v12
    v_cmp_le_i32_e64 s[80:81], 16, v12
    v_cmp_le_i32_e64 s[82:83], 17, v12
    v_cmp_le_i32_e64 s[84:85], 18, v12
    s_waitcnt lgkmcnt(6)
    v_mfma_f32_32x32x16_bf16 v[32:47], v[132:135], a[80:83], v[32:47]
    s_nop 0
    ds_read_b64_tr_b16 v[148:149], v213 offset:3136
    ds_read_b64_tr_b16 v[150:151], v213 offset:3904
    ds_read_b128 v[68:71], v8 offset:32
    v_cmp_le_i32_e64 s[86:87], 19, v12
    v_cmp_le_i32_e64 s[88:89], 24, v12
    v_cmp_le_i32_e64 s[90:91], 25, v12
    s_waitcnt lgkmcnt(7)
    v_mfma_f32_32x32x16_bf16 v[48:63], v[136:139], a[80:83], v[48:63]
    s_nop 0
    ds_read_b64_tr_b16 v[152:153], v213 offset:3200
    ds_read_b64_tr_b16 v[154:155], v213 offset:3968
    buffer_load_dwordx4 v202, s[36:39], s6 offen offset:3072 lds
    v_cmp_le_i32_e64 s[92:93], 26, v12
    v_cmp_le_i32_e64 s[94:95], 27, v12
    v_mov_b32 v12, 0xffff
    s_waitcnt lgkmcnt(6)
    v_mfma_f32_32x32x16_bf16 v[16:31], v[144:147], a[84:87], v[16:31]
    ds_read_b128 a[88:91], v205 offset:57344
    ds_read_b64_tr_b16 v[128:129], v213 offset:6144
    ds_read_b64_tr_b16 v[130:131], v213 offset:6912
    ds_read_b128 v[72:75], v8 offset:64
    s_add_u32 s22, s22, 1
    s_cmp_eq_u32 s22, 7
    s_cselect_b32 s22, 0, s22
    s_add_u32 m0, s23, 131072
    s_mul_i32 s6, s22, 229376
    buffer_load_dwordx4 v199, s[36:39], s6 offen offset:0 lds
    v_mov_b32 v13, 0xffff0000
    v_cndmask_b32_e64 v14, 0, v12, s[64:65]
    v_cndmask_b32_e64 v15, 0, v13, s[66:67]
    v_or_b32 v236, v14, v15
    s_waitcnt lgkmcnt(7)
    v_mfma_f32_32x32x16_bf16 v[32:47], v[148:151], a[84:87], v[32:47]
    ds_read_b64_tr_b16 v[132:133], v213 offset:6208
    ds_read_b64_tr_b16 v[134:135], v213 offset:6976
    ds_read_b128 v[76:79], v8 offset:96
    v_cndmask_b32_e64 v14, 0, v12, s[68:69]
    v_cndmask_b32_e64 v15, 0, v13, s[70:71]
    v_or_b32 v237, v14, v15
    s_waitcnt lgkmcnt(7)
    v_mfma_f32_32x32x16_bf16 v[48:63], v[152:155], a[84:87], v[48:63]
    ds_read_b64_tr_b16 v[136:137], v213 offset:6272
    ds_read_b64_tr_b16 v[138:139], v213 offset:7040
    buffer_load_dwordx4 v200, s[36:39], s6 offen offset:1024 lds
    v_cndmask_b32_e64 v14, 0, v12, s[72:73]
    v_cndmask_b32_e64 v15, 0, v13, s[74:75]
    v_or_b32 v238, v14, v15
    s_waitcnt lgkmcnt(6)
    v_mfma_f32_32x32x16_bf16 v[16:31], v[128:131], a[88:91], v[16:31]
    ds_read_b128 a[92:95], v206 offset:57344
    ds_read_b64_tr_b16 v[144:145], v213 offset:9216
    ds_read_b64_tr_b16 v[146:147], v213 offset:9984
    ds_read_b64_tr_b16 v[148:149], v213 offset:9280
    ds_read_b128 v[80:83], v8 offset:128
    v_cndmask_b32_e64 v14, 0, v12, s[76:77]
    v_cndmask_b32_e64 v15, 0, v13, s[78:79]
    v_or_b32 v239, v14, v15
    v_cndmask_b32_e64 v14, 0, v12, s[80:81]
    s_waitcnt lgkmcnt(8)
    v_mfma_f32_32x32x16_bf16 v[32:47], v[132:135], a[88:91], v[32:47]
    ds_read_b64_tr_b16 v[150:151], v213 offset:10048
    ds_read_b64_tr_b16 v[152:153], v213 offset:9344
    ds_read_b64_tr_b16 v[154:155], v213 offset:10112
    ds_read_b128 v[84:87], v8 offset:160
    buffer_load_dwordx4 v201, s[36:39], s6 offen offset:2048 lds
    v_cndmask_b32_e64 v15, 0, v13, s[82:83]
    v_or_b32 v240, v14, v15
    v_cndmask_b32_e64 v14, 0, v12, s[84:85]
    s_waitcnt lgkmcnt(9)
    v_mfma_f32_32x32x16_bf16 v[48:63], v[136:139], a[88:91], v[48:63]
    buffer_load_dwordx4 v202, s[36:39], s6 offen offset:3072 lds
    v_cndmask_b32_e64 v15, 0, v13, s[86:87]
    v_or_b32 v241, v14, v15
    v_cndmask_b32_e64 v14, 0, v12, s[88:89]
    s_waitcnt lgkmcnt(0)
    s_waitcnt vmcnt(8)
    s_barrier
    v_mfma_f32_32x32x16_bf16 v[16:31], v[144:147], a[92:95], v[16:31]
    ds_read_b128 a[96:99], v203 offset:0
    ds_read_b64_tr_b16 v[128:129], v207 offset:0
    ds_read_b64_tr_b16 v[130:131], v207 offset:768
    ds_read_b128 v[88:91], v8 offset:192
    v_cndmask_b32_e64 v15, 0, v13, s[90:91]
    v_or_b32 v242, v14, v15
    v_cndmask_b32_e64 v14, 0, v12, s[92:93]
    v_cndmask_b32_e64 v15, 0, v13, s[94:95]
    v_mfma_f32_32x32x16_bf16 v[32:47], v[148:151], a[92:95], v[32:47]
    ds_read_b64_tr_b16 v[132:133], v207 offset:64
    ds_read_b64_tr_b16 v[134:135], v207 offset:832
    ds_read_b128 v[92:95], v8 offset:224
    s_add_u32 s22, s22, 1
    s_cmp_eq_u32 s22, 7
    s_cselect_b32 s22, 0, s22
    s_add_u32 m0, s23, 147456
    s_mul_i32 s6, s22, 229376
    buffer_load_dwordx4 v199, s[36:39], s6 offen offset:0 lds
    v_or_b32 v243, v14, v15
    s_mul_i32 s26, s26, 0x9e3779b1
    s_add_u32 s26, s26, 0x7f4a7c15
    v_mfma_f32_32x32x16_bf16 v[48:63], v[152:155], a[92:95], v[48:63]
    ds_read_b64_tr_b16 v[136:137], v207 offset:128
    ds_read_b64_tr_b16 v[138:139], v207 offset:896
    s_xor_b32 s27, s26, 0x5bd1e995
    v_mov_b32 v6, s26
    v_mov_b32 v7, s27
    s_waitcnt lgkmcnt(6)
    v_mfma_f32_32x32x16_bf16 v[16:31], v[128:131], a[96:99], v[16:31]
    ds_read_b128 a[100:103], v204 offset:0
    ds_read_b64_tr_b16 v[144:145], v207 offset:3072
    ds_read_b64_tr_b16 v[146:147], v207 offset:3840
    ds_read_b128 v[96:99], v8 offset:256
    buffer_load_dwordx4 v200, s[36:39], s6 offen offset:1024 lds
    s_mul_i32 s57, s3, 3
    s_lshl2_add_u32 s57, s14, s57
    s_add_i32 s58, s57, -8
    s_waitcnt lgkmcnt(7)
    v_mfma_f32_32x32x16_bf16 v[32:47], v[132:135], a[96:99], v[32:47]
    ds_read_b64_tr_b16 v[148:149], v207 offset:3136
    ds_read_b64_tr_b16 v[150:151], v207 offset:3904
    ds_read_b128 v[100:103], v8 offset:288
    buffer_load_dwordx4 v201, s[36:39], s6 offen offset:2048 lds
    s_max_i32 s58, s58, 0
    s_mul_i32 s58, s58, 87040
    s_add_u32 s28, s58, 1048576
    s_waitcnt lgkmcnt(7)
    v_mfma_f32_32x32x16_bf16 v[48:63], v[136:139], a[96:99], v[48:63]
    ds_read_b64_tr_b16 v[152:153], v207 offset:3200
    ds_read_b64_tr_b16 v[154:155], v207 offset:3968
    s_add_i32 s58, s57, -7
    s_max_i32 s58, s58, 0
    s_waitcnt lgkmcnt(6)
    v_mfma_f32_32x32x16_bf16 v[16:31], v[144:147], a[100:103], v[16:31]
    s_nop 0
    ds_read_b128 a[104:107], v205 offset:0
    ds_read_b64_tr_b16 v[128:129], v207 offset:6144
    ds_read_b64_tr_b16 v[130:131], v207 offset:6912
    ds_read_b128 v[104:107], v8 offset:320
    buffer_load_dwordx4 v202, s[36:39], s6 offen offset:3072 lds
    s_mul_i32 s58, s58, 87040
    s_add_u32 s29, s58, 1048576
    s_add_i32 s58, s57, -6
    s_waitcnt lgkmcnt(7)
    v_mfma_f32_32x32x16_bf16 v[32:47], v[148:151], a[100:103], v[32:47]
    ds_read_b64_tr_b16 v[132:133], v207 offset:6208
    ds_read_b64_tr_b16 v[134:135], v207 offset:6976
    ds_read_b128 v[108:111], v8 offset:352
    s_max_i32 s58, s58, 0
    s_mul_i32 s58, s58, 87040
    s_add_u32 s30, s58, 1048576
    s_waitcnt lgkmcnt(7)
    v_mfma_f32_32x32x16_bf16 v[48:63], v[152:155], a[100:103], v[48:63]
    ds_read_b64_tr_b16 v[136:137], v207 offset:6272
    ds_read_b64_tr_b16 v[138:139], v207 offset:7040
    s_add_u32 s22, s22, 1
    s_cmp_eq_u32 s22, 7
    s_cselect_b32 s22, 0, s22
    s_add_u32 m0, s23, 98304
    s_mul_i32 s6, s22, 229376
    buffer_load_dwordx4 v199, s[36:39], s6 offen offset:0 lds
    s_mul_i32 s56, s100, 7
    s_lshr_b32 s56, s56, 1
    s_waitcnt lgkmcnt(6)
    v_mfma_f32_32x32x16_bf16 v[16:31], v[128:131], a[104:107], v[16:31]
    ds_read_b128 a[108:111], v206 offset:0
    ds_read_b64_tr_b16 v[144:145], v207 offset:9216
    ds_read_b64_tr_b16 v[146:147], v207 offset:9984
    ds_read_b64_tr_b16 v[148:149], v207 offset:9280
    ds_read_b128 v[112:115], v8 offset:384
    buffer_load_dwordx4 v200, s[36:39], s6 offen offset:1024 lds
    s_lshl_b32 s56, s56, 9
    s_mul_i32 s58, s15, 87040
    s_add_u32 s58, s58, s56
    s_waitcnt lgkmcnt(8)
    v_mfma_f32_32x32x16_bf16 v[32:47], v[132:135], a[104:107], v[32:47]
    s_nop 0
    ds_read_b64_tr_b16 v[150:151], v207 offset:10048
    ds_read_b64_tr_b16 v[152:153], v207 offset:9344
    ds_read_b64_tr_b16 v[154:155], v207 offset:10112
    ds_read_b128 v[116:119], v8 offset:416
    s_add_u32 s31, s58, 1048576
    s_mul_i32 s56, s98, 296960
    s_add_u32 s56, s56, 6815744
    s_waitcnt lgkmcnt(9)
    v_mfma_f32_32x32x16_bf16 v[48:63], v[136:139], a[104:107], v[48:63]
    buffer_load_dwordx4 v201, s[36:39], s6 offen offset:2048 lds
    s_lshl_b32 s58, s3, 13
    s_add_u32 s5, s56, s58
    s_waitcnt lgkmcnt(6)
    v_mfma_f32_32x32x16_bf16 v[16:31], v[144:147], a[108:111], v[16:31]
    ds_read_b128 v[120:123], v8 offset:448
    s_add_u32 s5, s5, 114688
    s_mul_i32 s58, s3, 28672
    s_add_u32 s4, s56, s58
    s_waitcnt lgkmcnt(4)
    v_mfma_f32_32x32x16_bf16 v[32:47], v[148:151], a[108:111], v[32:47]
    ds_read_b128 v[124:127], v8 offset:480
    buffer_load_dwordx4 v202, s[36:39], s6 offen offset:3072 lds
    s_mov_b64 s[32:33], s[20:21]
    s_mov_b32 s34, 401408
    s_mul_i32 s7, s3, 100352
    s_waitcnt lgkmcnt(3)
    v_mfma_f32_32x32x16_bf16 v[48:63], v[152:155], a[108:111], v[48:63]
    s_lshl_b32 s59, s99, 7
    s_add_u32 s7, s7, s59
    s_waitcnt lgkmcnt(0)
    s_waitcnt vmcnt(12)
    s_barrier
    s_nop 0
    ds_read_b64_tr_b16 v[128:129], v208 offset:16384
    ds_read_b64_tr_b16 v[130:131], v208 offset:17408
    ds_read_b64_tr_b16 v[132:133], v209 offset:16384
    ds_read_b64_tr_b16 v[134:135], v209 offset:17408
    ds_read_b64_tr_b16 v[136:137], v210 offset:16384
    ds_read_b64_tr_b16 v[138:139], v210 offset:17408
    ds_read_b64_tr_b16 v[140:141], v211 offset:16384
    ds_read_b64_tr_b16 v[142:143], v211 offset:17408
    s_mov_b32 s58, 0x3e8b97f6
    s_cmp_lt_u32 s19, 14
    s_cbranch_scc0 L_nosc0
    v_pk_mul_f32 v[16:17], v[16:17], s[58:59] op_sel_hi:[1,0]
    v_pk_mul_f32 v[18:19], v[18:19], s[58:59] op_sel_hi:[1,0]
    v_pk_mul_f32 v[20:21], v[20:21], s[58:59] op_sel_hi:[1,0]
    v_pk_mul_f32 v[22:23], v[22:23], s[58:59] op_sel_hi:[1,0]
    v_pk_mul_f32 v[24:25], v[24:25], s[58:59] op_sel_hi:[1,0]
    v_pk_mul_f32 v[26:27], v[26:27], s[58:59] op_sel_hi:[1,0]
    v_pk_mul_f32 v[28:29], v[28:29], s[58:59] op_sel_hi:[1,0]
    v_pk_mul_f32 v[30:31], v[30:31], s[58:59] op_sel_hi:[1,0]
L_nosc0:
    v_cvt_pk_bf16_f32 v160, v16, v17
    v_cvt_pk_bf16_f32 v161, v18, v19
    v_cvt_pk_bf16_f32 v162, v20, v21
    v_cvt_pk_bf16_f32 v163, v22, v23
    v_cvt_pk_bf16_f32 v164, v24, v25
    v_cvt_pk_bf16_f32 v165, v26, v27
    v_cvt_pk_bf16_f32 v166, v28, v29
    v_cvt_pk_bf16_f32 v167, v30, v31
    buffer_store_dwordx4 v[160:163], v2, s[40:43], s61 offen offset:0 sc1
    buffer_store_dwordx4 v[164:167], v2, s[40:43], s61 offen offset:1024 sc1
    s_cmp_lt_u32 s19, 13
    s_cbranch_scc0 L_nosc1
    v_pk_mul_f32 v[32:33], v[32:33], s[58:59] op_sel_hi:[1,0]
    v_pk_mul_f32 v[34:35], v[34:35], s[58:59] op_sel_hi:[1,0]
    v_pk_mul_f32 v[36:37], v[36:37], s[58:59] op_sel_hi:[1,0]
    v_pk_mul_f32 v[38:39], v[38:39], s[58:59] op_sel_hi:[1,0]
    v_pk_mul_f32 v[40:41], v[40:41], s[58:59] op_sel_hi:[1,0]
    v_pk_mul_f32 v[42:43], v[42:43], s[58:59] op_sel_hi:[1,0]
    v_pk_mul_f32 v[44:45], v[44:45], s[58:59] op_sel_hi:[1,0]
    v_pk_mul_f32 v[46:47], v[46:47], s[58:59] op_sel_hi:[1,0]
L_nosc1:
    v_cvt_pk_bf16_f32 v168, v32, v33
    v_cvt_pk_bf16_f32 v169, v34, v35
    v_cvt_pk_bf16_f32 v170, v36, v37
    v_cvt_pk_bf16_f32 v171, v38, v39
    v_cvt_pk_bf16_f32 v172, v40, v41
    v_cvt_pk_bf16_f32 v173, v42, v43
    v_cvt_pk_bf16_f32 v174, v44, v45
    v_cvt_pk_bf16_f32 v175, v46, v47
    buffer_store_dwordx4 v[168:171], v2, s[40:43], s61 offen offset:2048 sc1
    buffer_store_dwordx4 v[172:175], v2, s[40:43], s61 offen offset:3072 sc1
    s_cmp_lt_u32 s19, 12
    s_cbranch_scc0 L_nosc2
    v_pk_mul_f32 v[48:49], v[48:49], s[58:59] op_sel_hi:[1,0]
    v_pk_mul_f32 v[50:51], v[50:51], s[58:59] op_sel_hi:[1,0]
    v_pk_mul_f32 v[52:53], v[52:53], s[58:59] op_sel_hi:[1,0]
    v_pk_mul_f32 v[54:55], v[54:55], s[58:59] op_sel_hi:[1,0]
    v_pk_mul_f32 v[56:57], v[56:57], s[58:59] op_sel_hi:[1,0]
    v_pk_mul_f32 v[58:59], v[58:59], s[58:59] op_sel_hi:[1,0]
    v_pk_mul_f32 v[60:61], v[60:61], s[58:59] op_sel_hi:[1,0]
    v_pk_mul_f32 v[62:63], v[62:63], s[58:59] op_sel_hi:[1,0]
L_nosc2:
    v_cvt_pk_bf16_f32 v176, v48, v49
    v_cvt_pk_bf16_f32 v177, v50, v51
    v_cvt_pk_bf16_f32 v178, v52, v53
    v_cvt_pk_bf16_f32 v179, v54, v55
    v_cvt_pk_bf16_f32 v180, v56, v57
    v_cvt_pk_bf16_f32 v181, v58, v59
    v_cvt_pk_bf16_f32 v182, v60, v61
    v_cvt_pk_bf16_f32 v183, v62, v63
    buffer_store_dwordx4 v[176:179], v3, s[40:43], s61 offen offset:0 sc1
    buffer_store_dwordx4 v[180:183], v3, s[40:43], s61 offen offset:1024 sc1
    s_waitcnt lgkmcnt(6)
    v_mfma_f32_32x32x16_bf16 v[64:79], v[128:131], a[0:3], v[64:79]
    ds_read_b64_tr_b16 v[144:145], v208 offset:20480
    ds_read_b64_tr_b16 v[146:147], v208 offset:21504
    s_lshl_b32 s56, s99, 7
    s_waitcnt lgkmcnt(6)
    v_mfma_f32_32x32x16_bf16 v[80:95], v[132:135], a[0:3], v[80:95]
    ds_read_b64_tr_b16 v[148:149], v209 offset:20480
    ds_read_b64_tr_b16 v[150:151], v209 offset:21504
    v_and_b32 v11, 31, v1
    s_waitcnt lgkmcnt(6)
    v_mfma_f32_32x32x16_bf16 v[96:111], v[136:139], a[0:3], v[96:111]
    ds_read_b64_tr_b16 v[152:153], v210 offset:20480
    ds_read_b64_tr_b16 v[154:155], v210 offset:21504
    s_and_b32 s57, s3, 1
    s_waitcnt lgkmcnt(6)
    v_mfma_f32_32x32x16_bf16 v[112:127], v[140:143], a[0:3], v[112:127]
    ds_read_b64_tr_b16 v[156:157], v211 offset:20480
    ds_read_b64_tr_b16 v[158:159], v211 offset:21504
    s_mul_i32 s58, s57, 148480
    s_waitcnt lgkmcnt(6)
    v_mfma_f32_32x32x16_bf16 v[64:79], v[144:147], a[4:7], v[64:79]
    ds_read_b64_tr_b16 v[128:129], v208 offset:24576
    ds_read_b64_tr_b16 v[130:131], v208 offset:25600
    s_sub_u32 s59, 148480, s58
    s_waitcnt lgkmcnt(6)
    v_mfma_f32_32x32x16_bf16 v[80:95], v[148:151], a[4:7], v[80:95]
    ds_read_b64_tr_b16 v[132:133], v209 offset:24576
    ds_read_b64_tr_b16 v[134:135], v209 offset:25600
    v_add_u32 v220, s59, v2
    s_waitcnt lgkmcnt(6)
    v_mfma_f32_32x32x16_bf16 v[96:111], v[152:155], a[4:7], v[96:111]
    ds_read_b64_tr_b16 v[136:137], v210 offset:24576
    ds_read_b64_tr_b16 v[138:139], v210 offset:25600
    v_add_u32 v221, s58, v2
    s_waitcnt lgkmcnt(6)
    v_mfma_f32_32x32x16_bf16 v[112:127], v[156:159], a[4:7], v[112:127]
    ds_read_b64_tr_b16 v[140:141], v211 offset:24576
    ds_read_b64_tr_b16 v[142:143], v211 offset:25600
    v_and_b32 v12, 1, v1
    s_waitcnt lgkmcnt(6)
    v_mfma_f32_32x32x16_bf16 v[64:79], v[128:131], a[8:11], v[64:79]
    ds_read_b64_tr_b16 v[144:145], v208 offset:28672
    ds_read_b64_tr_b16 v[146:147], v208 offset:29696
    ds_read_b64_tr_b16 v[148:149], v209 offset:28672
    s_lshl_b32 s56, s98, 1
    s_waitcnt lgkmcnt(7)
    v_mfma_f32_32x32x16_bf16 v[80:95], v[132:135], a[8:11], v[80:95]
    ds_read_b64_tr_b16 v[150:151], v209 offset:29696
    ds_read_b64_tr_b16 v[152:153], v210 offset:28672
    ds_read_b64_tr_b16 v[154:155], v210 offset:29696
    v_add_u32 v12, s56, v12
    s_waitcnt lgkmcnt(8)
    v_mfma_f32_32x32x16_bf16 v[96:111], v[136:139], a[8:11], v[96:111]
    ds_read_b64_tr_b16 v[156:157], v211 offset:28672
    ds_read_b64_tr_b16 v[158:159], v211 offset:29696
    v_lshlrev_b32 v12, 4, v12
    s_waitcnt lgkmcnt(8)
    v_mfma_f32_32x32x16_bf16 v[112:127], v[140:143], a[8:11], v[112:127]
    v_bfe_u32 v13, v1, 1, 2
    s_waitcnt lgkmcnt(0)
    s_waitcnt vmcnt(14)
    s_barrier
    v_mfma_f32_32x32x16_bf16 v[64:79], v[144:147], a[12:15], v[64:79]
    ds_read_b64_tr_b16 v[128:129], v208 offset:32768
    ds_read_b64_tr_b16 v[130:131], v208 offset:33792
    s_add_u32 s22, s22, 1
    s_cmp_eq_u32 s22, 7
    s_cselect_b32 s22, 0, s22
    s_add_u32 m0, s23, 114688
    s_mul_i32 s6, s22, 229376
    buffer_load_dwordx4 v199, s[36:39], s6 offen offset:0 lds
    v_add_u32 v12, v12, v13
    v_mfma_f32_32x32x16_bf16 v[80:95], v[148:151], a[12:15], v[80:95]
    ds_read_b64_tr_b16 v[132:133], v209 offset:32768
    ds_read_b64_tr_b16 v[134:135], v209 offset:33792
    v_lshlrev_b32 v12, 7, v12
    v_mfma_f32_32x32x16_bf16 v[96:111], v[152:155], a[12:15], v[96:111]
    ds_read_b64_tr_b16 v[136:137], v210 offset:32768
    ds_read_b64_tr_b16 v[138:139], v210 offset:33792
    buffer_load_dwordx4 v200, s[36:39], s6 offen offset:1024 lds
    s_mul_i32 s56, s3, 7
    v_mfma_f32_32x32x16_bf16 v[112:127], v[156:159], a[12:15], v[112:127]
    ds_read_b64_tr_b16 v[140:141], v211 offset:32768
    ds_read_b64_tr_b16 v[142:143], v211 offset:33792
    s_lshr_b32 s56, s56, 1
    s_waitcnt lgkmcnt(6)
    v_mfma_f32_32x32x16_bf16 v[64:79], v[128:131], a[16:19], v[64:79]
    ds_read_b64_tr_b16 v[144:145], v208 offset:36864
    ds_read_b64_tr_b16 v[146:147], v208 offset:37888
    buffer_load_dwordx4 v201, s[36:39], s6 offen offset:2048 lds
    s_lshl_b32 s56, s56, 7
    s_waitcnt lgkmcnt(6)
    v_mfma_f32_32x32x16_bf16 v[80:95], v[132:135], a[16:19], v[80:95]
    ds_read_b64_tr_b16 v[148:149], v209 offset:36864
    ds_read_b64_tr_b16 v[150:151], v209 offset:37888
    s_add_u32 s56, s56, 262144
    s_waitcnt lgkmcnt(6)
    v_mfma_f32_32x32x16_bf16 v[96:111], v[136:139], a[16:19], v[96:111]
    ds_read_b64_tr_b16 v[152:153], v210 offset:36864
    ds_read_b64_tr_b16 v[154:155], v210 offset:37888
    buffer_load_dwordx4 v202, s[36:39], s6 offen offset:3072 lds
    v_add_u32 v231, s56, v12
    s_waitcnt lgkmcnt(6)
    v_mfma_f32_32x32x16_bf16 v[112:127], v[140:143], a[16:19], v[112:127]
    ds_read_b64_tr_b16 v[156:157], v211 offset:36864
    ds_read_b64_tr_b16 v[158:159], v211 offset:37888
    s_lshl_b32 s56, s3, 9
    s_waitcnt lgkmcnt(6)
    v_mfma_f32_32x32x16_bf16 v[64:79], v[144:147], a[20:23], v[64:79]
    ds_read_b64_tr_b16 v[128:129], v208 offset:40960
    ds_read_b64_tr_b16 v[130:131], v208 offset:41984
    s_add_u32 s56, s56, 393216
    s_waitcnt lgkmcnt(6)
    v_mfma_f32_32x32x16_bf16 v[80:95], v[148:151], a[20:23], v[80:95]
    ds_read_b64_tr_b16 v[132:133], v209 offset:40960
    ds_read_b64_tr_b16 v[134:135], v209 offset:41984
    v_add_u32 v229, s56, v12
    s_waitcnt lgkmcnt(6)
    v_mfma_f32_32x32x16_bf16 v[96:111], v[152:155], a[20:23], v[96:111]
    ds_read_b64_tr_b16 v[136:137], v210 offset:40960
    ds_read_b64_tr_b16 v[138:139], v210 offset:41984
    s_xor_b32 s56, s3, 1
    s_waitcnt lgkmcnt(6)
    v_mfma_f32_32x32x16_bf16 v[112:127], v[156:159], a[20:23], v[112:127]
    ds_read_b64_tr_b16 v[140:141], v211 offset:40960
    ds_read_b64_tr_b16 v[142:143], v211 offset:41984
    s_lshl_b32 s56, s56, 12
    s_waitcnt lgkmcnt(6)
    v_mfma_f32_32x32x16_bf16 v[64:79], v[128:131], a[24:27], v[64:79]
    ds_read_b64_tr_b16 v[144:145], v208 offset:45056
    ds_read_b64_tr_b16 v[146:147], v208 offset:46080
    ds_read_b64_tr_b16 v[148:149], v209 offset:45056
    s_waitcnt lgkmcnt(7)
    v_mfma_f32_32x32x16_bf16 v[80:95], v[132:135], a[24:27], v[80:95]
    ds_read_b64_tr_b16 v[150:151], v209 offset:46080
    ds_read_b64_tr_b16 v[152:153], v210 offset:45056
    ds_read_b64_tr_b16 v[154:155], v210 offset:46080
    s_add_u32 s56, s56, 65536
    s_waitcnt lgkmcnt(8)
    v_mfma_f32_32x32x16_bf16 v[96:111], v[136:139], a[24:27], v[96:111]
    ds_read_b64_tr_b16 v[156:157], v211 offset:45056
    ds_read_b64_tr_b16 v[158:159], v211 offset:46080
    v_add_u32 v224, s56, v2
    s_waitcnt lgkmcnt(8)
    v_mfma_f32_32x32x16_bf16 v[112:127], v[140:143], a[24:27], v[112:127]
    s_xor_b32 s56, s3, 2
    s_waitcnt lgkmcnt(0)
    s_waitcnt vmcnt(14)
    s_barrier
    v_mfma_f32_32x32x16_bf16 v[64:79], v[144:147], a[28:31], v[64:79]
    ds_read_b64_tr_b16 v[128:129], v208 offset:49152
    ds_read_b64_tr_b16 v[130:131], v208 offset:50176
    s_add_u32 s22, s22, 1
    s_cmp_eq_u32 s22, 7
    s_cselect_b32 s22, 0, s22
    s_add_u32 m0, s23, 131072
    s_mul_i32 s6, s22, 229376
    buffer_load_dwordx4 v199, s[36:39], s6 offen offset:0 lds
    s_lshl_b32 s56, s56, 12
    v_mfma_f32_32x32x16_bf16 v[80:95], v[148:151], a[28:31], v[80:95]
    ds_read_b64_tr_b16 v[132:133], v209 offset:49152
    ds_read_b64_tr_b16 v[134:135], v209 offset:50176
    s_add_u32 s56, s56, 81920
    v_mfma_f32_32x32x16_bf16 v[96:111], v[152:155], a[28:31], v[96:111]
    ds_read_b64_tr_b16 v[136:137], v210 offset:49152
    ds_read_b64_tr_b16 v[138:139], v210 offset:50176
    buffer_load_dwordx4 v200, s[36:39], s6 offen offset:1024 lds
    s_waitcnt vmcnt(6)
    buffer_store_dwordx2 v[6:7], v4, s[40:43], s12 offen sc1
    v_add_u32 v225, s56, v2
    v_mfma_f32_32x32x16_bf16 v[112:127], v[156:159], a[28:31], v[112:127]
    ds_read_b64_tr_b16 v[140:141], v211 offset:49152
    ds_read_b64_tr_b16 v[142:143], v211 offset:50176
    s_xor_b32 s56, s3, 3
    s_waitcnt lgkmcnt(6)
    v_mfma_f32_32x32x16_bf16 v[64:79], v[128:131], a[32:35], v[64:79]
    ds_read_b64_tr_b16 v[144:145], v208 offset:53248
    ds_read_b64_tr_b16 v[146:147], v208 offset:54272
    buffer_load_dwordx4 v201, s[36:39], s6 offen offset:2048 lds
    s_lshl_b32 s56, s56, 12
    s_waitcnt lgkmcnt(6)
    v_mfma_f32_32x32x16_bf16 v[80:95], v[132:135], a[32:35], v[80:95]
    ds_read_b64_tr_b16 v[148:149], v209 offset:53248
    ds_read_b64_tr_b16 v[150:151], v209 offset:54272
    s_add_u32 s56, s56, 98304
    s_waitcnt lgkmcnt(6)
    v_mfma_f32_32x32x16_bf16 v[96:111], v[136:139], a[32:35], v[96:111]
    ds_read_b64_tr_b16 v[152:153], v210 offset:53248
    ds_read_b64_tr_b16 v[154:155], v210 offset:54272
    buffer_load_dwordx4 v202, s[36:39], s6 offen offset:3072 lds
    v_add_u32 v226, s56, v2
    s_waitcnt lgkmcnt(6)
    v_mfma_f32_32x32x16_bf16 v[112:127], v[140:143], a[32:35], v[112:127]
    ds_read_b64_tr_b16 v[156:157], v211 offset:53248
    ds_read_b64_tr_b16 v[158:159], v211 offset:54272
    s_add_u32 s56, s23, 65536
    s_waitcnt lgkmcnt(6)
    v_mfma_f32_32x32x16_bf16 v[64:79], v[144:147], a[36:39], v[64:79]
    ds_read_b64_tr_b16 v[128:129], v208 offset:57344
    ds_read_b64_tr_b16 v[130:131], v208 offset:58368
    v_add_u32 v227, s56, v2
    s_waitcnt lgkmcnt(6)
    v_mfma_f32_32x32x16_bf16 v[80:95], v[148:151], a[36:39], v[80:95]
    ds_read_b64_tr_b16 v[132:133], v209 offset:57344
    ds_read_b64_tr_b16 v[134:135], v209 offset:58368
    s_lshl_b32 s56, s98, 6
    s_waitcnt lgkmcnt(6)
    v_mfma_f32_32x32x16_bf16 v[96:111], v[152:155], a[36:39], v[96:111]
    ds_read_b64_tr_b16 v[136:137], v210 offset:57344
    ds_read_b64_tr_b16 v[138:139], v210 offset:58368
    s_lshl_b32 s58, s57, 5
    s_waitcnt lgkmcnt(6)
    v_mfma_f32_32x32x16_bf16 v[112:127], v[156:159], a[36:39], v[112:127]
    ds_read_b64_tr_b16 v[140:141], v211 offset:57344
    ds_read_b64_tr_b16 v[142:143], v211 offset:58368
    s_add_u32 s56, s56, s58
    s_waitcnt lgkmcnt(6)
    v_mfma_f32_32x32x16_bf16 v[64:79], v[128:131], a[40:43], v[64:79]
    ds_read_b64_tr_b16 v[144:145], v208 offset:61440
    ds_read_b64_tr_b16 v[146:147], v208 offset:62464
    ds_read_b64_tr_b16 v[148:149], v209 offset:61440
    v_add_u32 v12, s56, v11
    s_waitcnt lgkmcnt(7)
    v_mfma_f32_32x32x16_bf16 v[80:95], v[132:135], a[40:43], v[80:95]
    ds_read_b64_tr_b16 v[150:151], v209 offset:62464
    ds_read_b64_tr_b16 v[152:153], v210 offset:61440
    ds_read_b64_tr_b16 v[154:155], v210 offset:62464
    v_mul_u32_u24 v12, 896, v12
    s_waitcnt lgkmcnt(8)
    v_mfma_f32_32x32x16_bf16 v[96:111], v[136:139], a[40:43], v[96:111]
    ds_read_b64_tr_b16 v[156:157], v211 offset:61440
    ds_read_b64_tr_b16 v[158:159], v211 offset:62464
    v_lshrrev_b32 v13, 5, v1
    s_waitcnt lgkmcnt(8)
    v_mfma_f32_32x32x16_bf16 v[112:127], v[140:143], a[40:43], v[112:127]
    v_lshl_add_u32 v12, v13, 4, v12
    s_waitcnt lgkmcnt(0)
    s_barrier
    v_mfma_f32_32x32x16_bf16 v[64:79], v[144:147], a[44:47], v[64:79]
    ds_read_b64_tr_b16 v[128:129], v208 offset:0
    ds_read_b64_tr_b16 v[130:131], v208 offset:1024
    s_add_u32 s22, s22, 1
    s_cmp_eq_u32 s22, 7
    s_cselect_b32 s22, 0, s22
    s_add_u32 m0, s23, 147456
    s_mul_i32 s6, s22, 229376
    buffer_load_dwordx4 v199, s[36:39], s6 offen offset:0 lds
    s_lshl_b32 s56, s99, 7
    v_mfma_f32_32x32x16_bf16 v[80:95], v[148:151], a[44:47], v[80:95]
    ds_read_b64_tr_b16 v[132:133], v209 offset:0
    ds_read_b64_tr_b16 v[134:135], v209 offset:1024
    s_lshr_b32 s58, s3, 1
    v_mfma_f32_32x32x16_bf16 v[96:111], v[152:155], a[44:47], v[96:111]
    ds_read_b64_tr_b16 v[136:137], v210 offset:0
    ds_read_b64_tr_b16 v[138:139], v210 offset:1024
    buffer_load_dwordx4 v200, s[36:39], s6 offen offset:1024 lds
    s_lshl_b32 s58, s58, 6
    v_mfma_f32_32x32x16_bf16 v[112:127], v[156:159], a[44:47], v[112:127]
    ds_read_b64_tr_b16 v[140:141], v211 offset:0
    ds_read_b64_tr_b16 v[142:143], v211 offset:1024
    s_add_u32 s56, s56, s58
    s_waitcnt lgkmcnt(6)
    v_mfma_f32_32x32x16_bf16 v[64:79], v[128:131], a[48:51], v[64:79]
    ds_read_b64_tr_b16 v[144:145], v208 offset:4096
    ds_read_b64_tr_b16 v[146:147], v208 offset:5120
    buffer_load_dwordx4 v201, s[36:39], s6 offen offset:2048 lds
    v_add_u32 v228, s56, v12
    s_waitcnt lgkmcnt(6)
    v_mfma_f32_32x32x16_bf16 v[80:95], v[132:135], a[48:51], v[80:95]
    ds_read_b64_tr_b16 v[148:149], v209 offset:4096
    ds_read_b64_tr_b16 v[150:151], v209 offset:5120
    s_waitcnt lgkmcnt(6)
    v_mfma_f32_32x32x16_bf16 v[96:111], v[136:139], a[48:51], v[96:111]
    ds_read_b64_tr_b16 v[152:153], v210 offset:4096
    ds_read_b64_tr_b16 v[154:155], v210 offset:5120
    buffer_load_dwordx4 v202, s[36:39], s6 offen offset:3072 lds
    s_waitcnt lgkmcnt(6)
    v_mfma_f32_32x32x16_bf16 v[112:127], v[140:143], a[48:51], v[112:127]
    ds_read_b64_tr_b16 v[156:157], v211 offset:4096
    ds_read_b64_tr_b16 v[158:159], v211 offset:5120
    s_waitcnt lgkmcnt(6)
    v_mfma_f32_32x32x16_bf16 v[64:79], v[144:147], a[52:55], v[64:79]
    ds_read_b64_tr_b16 v[128:129], v208 offset:8192
    ds_read_b64_tr_b16 v[130:131], v208 offset:9216
    s_add_u32 m0, s23, 49152
    s_nop 0
    buffer_load_dwordx4 v216, s[48:51], s55 offen offset:0 lds
    s_waitcnt lgkmcnt(6)
    v_mfma_f32_32x32x16_bf16 v[80:95], v[148:151], a[52:55], v[80:95]
    ds_read_b64_tr_b16 v[132:133], v209 offset:8192
    ds_read_b64_tr_b16 v[134:135], v209 offset:9216
    s_waitcnt lgkmcnt(6)
    v_mfma_f32_32x32x16_bf16 v[96:111], v[152:155], a[52:55], v[96:111]
    ds_read_b64_tr_b16 v[136:137], v210 offset:8192
    ds_read_b64_tr_b16 v[138:139], v210 offset:9216
    buffer_load_dwordx4 v217, s[48:51], s55 offen offset:1024 lds
    s_waitcnt lgkmcnt(6)
    v_mfma_f32_32x32x16_bf16 v[112:127], v[156:159], a[52:55], v[112:127]
    ds_read_b64_tr_b16 v[140:141], v211 offset:8192
    ds_read_b64_tr_b16 v[142:143], v211 offset:9216
    s_waitcnt lgkmcnt(6)
    v_mfma_f32_32x32x16_bf16 v[64:79], v[128:131], a[56:59], v[64:79]
    ds_read_b64_tr_b16 v[144:145], v208 offset:12288
    ds_read_b64_tr_b16 v[146:147], v208 offset:13312
    ds_read_b64_tr_b16 v[148:149], v209 offset:12288
    buffer_load_dwordx4 v218, s[48:51], s55 offen offset:2048 lds
    s_waitcnt lgkmcnt(7)
    v_mfma_f32_32x32x16_bf16 v[80:95], v[132:135], a[56:59], v[80:95]
    ds_read_b64_tr_b16 v[150:151], v209 offset:13312
    ds_read_b64_tr_b16 v[152:153], v210 offset:12288
    ds_read_b64_tr_b16 v[154:155], v210 offset:13312
    s_waitcnt lgkmcnt(8)
    v_mfma_f32_32x32x16_bf16 v[96:111], v[136:139], a[56:59], v[96:111]
    ds_read_b64_tr_b16 v[156:157], v211 offset:12288
    ds_read_b64_tr_b16 v[158:159], v211 offset:13312
    buffer_load_dwordx4 v219, s[48:51], s55 offen offset:3072 lds
    s_waitcnt lgkmcnt(8)
    v_mfma_f32_32x32x16_bf16 v[112:127], v[140:143], a[56:59], v[112:127]
    s_waitcnt lgkmcnt(0)
    s_waitcnt vmcnt(13)
    s_barrier
    v_mfma_f32_32x32x16_bf16 v[64:79], v[144:147], a[60:63], v[64:79]
    ds_read_b64_tr_b16 v[128:129], v208 offset:16384
    ds_read_b64_tr_b16 v[130:131], v208 offset:17408
    s_add_u32 m0, s23, 65536
    s_add_u32 s55, s55, 28672
    buffer_load_dwordx4 v216, s[48:51], s55 offen offset:0 lds
    v_mfma_f32_32x32x16_bf16 v[80:95], v[148:151], a[60:63], v[80:95]
    ds_read_b64_tr_b16 v[132:133], v209 offset:16384
    ds_read_b64_tr_b16 v[134:135], v209 offset:17408
    v_mfma_f32_32x32x16_bf16 v[96:111], v[152:155], a[60:63], v[96:111]
    ds_read_b64_tr_b16 v[136:137], v210 offset:16384
    ds_read_b64_tr_b16 v[138:139], v210 offset:17408
    buffer_load_dwordx4 v217, s[48:51], s55 offen offset:1024 lds
    v_mfma_f32_32x32x16_bf16 v[112:127], v[156:159], a[60:63], v[112:127]
    ds_read_b64_tr_b16 v[140:141], v211 offset:16384
    ds_read_b64_tr_b16 v[142:143], v211 offset:17408
    s_waitcnt lgkmcnt(6)
    v_mfma_f32_32x32x16_bf16 v[64:79], v[128:131], a[64:67], v[64:79]
    ds_read_b64_tr_b16 v[144:145], v208 offset:20480
    ds_read_b64_tr_b16 v[146:147], v208 offset:21504
    buffer_load_dwordx4 v218, s[48:51], s55 offen offset:2048 lds
    s_waitcnt lgkmcnt(6)
    v_mfma_f32_32x32x16_bf16 v[80:95], v[132:135], a[64:67], v[80:95]
    ds_read_b64_tr_b16 v[148:149], v209 offset:20480
    ds_read_b64_tr_b16 v[150:151], v209 offset:21504
    s_waitcnt lgkmcnt(6)
    v_mfma_f32_32x32x16_bf16 v[96:111], v[136:139], a[64:67], v[96:111]
    ds_read_b64_tr_b16 v[152:153], v210 offset:20480
    ds_read_b64_tr_b16 v[154:155], v210 offset:21504
    buffer_load_dwordx4 v219, s[48:51], s55 offen offset:3072 lds
    s_waitcnt lgkmcnt(6)
    v_mfma_f32_32x32x16_bf16 v[112:127], v[140:143], a[64:67], v[112:127]
    ds_read_b64_tr_b16 v[156:157], v211 offset:20480
    ds_read_b64_tr_b16 v[158:159], v211 offset:21504
    s_waitcnt lgkmcnt(6)
    v_mfma_f32_32x32x16_bf16 v[64:79], v[144:147], a[68:71], v[64:79]
    ds_read_b64_tr_b16 v[128:129], v208 offset:24576
    ds_read_b64_tr_b16 v[130:131], v208 offset:25600
    s_add_u32 m0, s23, 81920
    s_add_u32 s55, s55, 28672
    buffer_load_dwordx4 v216, s[48:51], s55 offen offset:0 lds
    s_waitcnt lgkmcnt(6)
    v_mfma_f32_32x32x16_bf16 v[80:95], v[148:151], a[68:71], v[80:95]
    ds_read_b64_tr_b16 v[132:133], v209 offset:24576
    ds_read_b64_tr_b16 v[134:135], v209 offset:25600
    s_waitcnt lgkmcnt(6)
    v_mfma_f32_32x32x16_bf16 v[96:111], v[152:155], a[68:71], v[96:111]
    ds_read_b64_tr_b16 v[136:137], v210 offset:24576
    ds_read_b64_tr_b16 v[138:139], v210 offset:25600
    buffer_load_dwordx4 v217, s[48:51], s55 offen offset:1024 lds
    s_waitcnt lgkmcnt(6)
    v_mfma_f32_32x32x16_bf16 v[112:127], v[156:159], a[68:71], v[112:127]
    ds_read_b64_tr_b16 v[140:141], v211 offset:24576
    ds_read_b64_tr_b16 v[142:143], v211 offset:25600
    s_waitcnt lgkmcnt(6)
    v_mfma_f32_32x32x16_bf16 v[64:79], v[128:131], a[72:75], v[64:79]
    ds_read_b64_tr_b16 v[144:145], v208 offset:28672
    ds_read_b64_tr_b16 v[146:147], v208 offset:29696
    ds_read_b64_tr_b16 v[148:149], v209 offset:28672
    buffer_load_dwordx4 v218, s[48:51], s55 offen offset:2048 lds
    s_waitcnt lgkmcnt(7)
    v_mfma_f32_32x32x16_bf16 v[80:95], v[132:135], a[72:75], v[80:95]
    ds_read_b64_tr_b16 v[150:151], v209 offset:29696
    ds_read_b64_tr_b16 v[152:153], v210 offset:28672
    ds_read_b64_tr_b16 v[154:155], v210 offset:29696
    s_waitcnt lgkmcnt(8)
    v_mfma_f32_32x32x16_bf16 v[96:111], v[136:139], a[72:75], v[96:111]
    ds_read_b64_tr_b16 v[156:157], v211 offset:28672
    ds_read_b64_tr_b16 v[158:159], v211 offset:29696
    buffer_load_dwordx4 v219, s[48:51], s55 offen offset:3072 lds
    buffer_load_dwordx2 v[8:9], v10, s[40:43], 0 offen sc1
    s_waitcnt lgkmcnt(8)
    v_mfma_f32_32x32x16_bf16 v[112:127], v[140:143], a[72:75], v[112:127]
    s_waitcnt lgkmcnt(0)
    s_waitcnt vmcnt(17)
    s_barrier
    v_mfma_f32_32x32x16_bf16 v[64:79], v[144:147], a[76:79], v[64:79]
    ds_read_b64_tr_b16 v[128:129], v208 offset:32768
    ds_read_b64_tr_b16 v[130:131], v208 offset:33792
    s_add_u32 m0, s23, 98304
    s_add_u32 s55, s55, 28672
    buffer_load_dwordx4 v216, s[48:51], s55 offen offset:0 lds
    v_mfma_f32_32x32x16_bf16 v[80:95], v[148:151], a[76:79], v[80:95]
    ds_read_b64_tr_b16 v[132:133], v209 offset:32768
    ds_read_b64_tr_b16 v[134:135], v209 offset:33792
    v_mfma_f32_32x32x16_bf16 v[96:111], v[152:155], a[76:79], v[96:111]
    ds_read_b64_tr_b16 v[136:137], v210 offset:32768
    ds_read_b64_tr_b16 v[138:139], v210 offset:33792
    buffer_load_dwordx4 v217, s[48:51], s55 offen offset:1024 lds
    v_mfma_f32_32x32x16_bf16 v[112:127], v[156:159], a[76:79], v[112:127]
    ds_read_b64_tr_b16 v[140:141], v211 offset:32768
    ds_read_b64_tr_b16 v[142:143], v211 offset:33792
    s_waitcnt lgkmcnt(6)
    v_mfma_f32_32x32x16_bf16 v[64:79], v[128:131], a[80:83], v[64:79]
    ds_read_b64_tr_b16 v[144:145], v208 offset:36864
    ds_read_b64_tr_b16 v[146:147], v208 offset:37888
    buffer_load_dwordx4 v218, s[48:51], s55 offen offset:2048 lds
    s_waitcnt lgkmcnt(6)
    v_mfma_f32_32x32x16_bf16 v[80:95], v[132:135], a[80:83], v[80:95]
    ds_read_b64_tr_b16 v[148:149], v209 offset:36864
    ds_read_b64_tr_b16 v[150:151], v209 offset:37888
    s_waitcnt lgkmcnt(6)
    v_mfma_f32_32x32x16_bf16 v[96:111], v[136:139], a[80:83], v[96:111]
    ds_read_b64_tr_b16 v[152:153], v210 offset:36864
    ds_read_b64_tr_b16 v[154:155], v210 offset:37888
    buffer_load_dwordx4 v219, s[48:51], s55 offen offset:3072 lds
    s_waitcnt lgkmcnt(6)
    v_mfma_f32_32x32x16_bf16 v[112:127], v[140:143], a[80:83], v[112:127]
    ds_read_b64_tr_b16 v[156:157], v211 offset:36864
    ds_read_b64_tr_b16 v[158:159], v211 offset:37888
    s_waitcnt lgkmcnt(6)
    v_mfma_f32_32x32x16_bf16 v[64:79], v[144:147], a[84:87], v[64:79]
    ds_read_b64_tr_b16 v[128:129], v208 offset:40960
    ds_read_b64_tr_b16 v[130:131], v208 offset:41984
    s_waitcnt lgkmcnt(6)
    v_mfma_f32_32x32x16_bf16 v[80:95], v[148:151], a[84:87], v[80:95]
    ds_read_b64_tr_b16 v[132:133], v209 offset:40960
    ds_read_b64_tr_b16 v[134:135], v209 offset:41984
    s_waitcnt lgkmcnt(6)
    v_mfma_f32_32x32x16_bf16 v[96:111], v[152:155], a[84:87], v[96:111]
    ds_read_b64_tr_b16 v[136:137], v210 offset:40960
    ds_read_b64_tr_b16 v[138:139], v210 offset:41984
    s_waitcnt vmcnt(4)
    v_cmp_ne_u64 vcc, s[26:27], v[8:9]
    s_cbranch_vccnz L_pc1_slow
L_pc1_back:
    s_mul_i32 s59, s3, 12288
    s_add_u32 m0, s59, 0
    s_nop 0
    buffer_load_dwordx4 v247, s[40:43], s28 offen offset:0 sc1 lds
    s_waitcnt lgkmcnt(6)
    v_mfma_f32_32x32x16_bf16 v[112:127], v[156:159], a[84:87], v[112:127]
    ds_read_b64_tr_b16 v[140:141], v211 offset:40960
    ds_read_b64_tr_b16 v[142:143], v211 offset:41984
    s_waitcnt lgkmcnt(6)
    v_mfma_f32_32x32x16_bf16 v[64:79], v[128:131], a[88:91], v[64:79]
    ds_read_b64_tr_b16 v[144:145], v208 offset:45056
    ds_read_b64_tr_b16 v[146:147], v208 offset:46080
    ds_read_b64_tr_b16 v[148:149], v209 offset:45056
    buffer_load_dwordx4 v247, s[40:43], s28 offen offset:1024 sc1 lds
    ds_read_b64_tr_b16 a[112:113], v232 offset:49152
    ds_read_b64_tr_b16 a[114:115], v232 offset:50176
    s_waitcnt lgkmcnt(9)
    v_mfma_f32_32x32x16_bf16 v[80:95], v[132:135], a[88:91], v[80:95]
    ds_read_b64_tr_b16 v[150:151], v209 offset:46080
    ds_read_b64_tr_b16 v[152:153], v210 offset:45056
    ds_read_b64_tr_b16 v[154:155], v210 offset:46080
    ds_read_b64_tr_b16 a[116:117], v233 offset:49152
    ds_read_b64_tr_b16 a[118:119], v233 offset:50176
    s_waitcnt lgkmcnt(12)
    v_mfma_f32_32x32x16_bf16 v[96:111], v[136:139], a[88:91], v[96:111]
    ds_read_b64_tr_b16 v[156:157], v211 offset:45056
    ds_read_b64_tr_b16 v[158:159], v211 offset:46080
    buffer_load_dwordx4 v248, s[40:43], s28 offen offset:2048 sc1 lds
    ds_read_b64_tr_b16 a[120:121], v232 offset:51200
    ds_read_b64_tr_b16 a[122:123], v232 offset:52224
    s_waitcnt lgkmcnt(14)
    v_mfma_f32_32x32x16_bf16 v[112:127], v[140:143], a[88:91], v[112:127]
    ds_read_b64_tr_b16 a[124:125], v233 offset:51200
    ds_read_b64_tr_b16 a[126:127], v233 offset:52224
    s_waitcnt lgkmcnt(0)
    s_barrier
    v_mfma_f32_32x32x16_bf16 v[64:79], v[144:147], a[92:95], v[64:79]
    ds_read_b64_tr_b16 v[128:129], v208 offset:49152
    ds_read_b64_tr_b16 v[130:131], v208 offset:50176
    buffer_load_dwordx4 v249, s[40:43], s28 offen offset:3072 sc1 lds
    ds_read_b64_tr_b16 a[128:129], v0 offset:0
    ds_read_b64_tr_b16 a[130:131], v0 offset:1024
    v_mfma_f32_32x32x16_bf16 v[80:95], v[148:151], a[92:95], v[80:95]
    ds_read_b64_tr_b16 v[132:133], v209 offset:49152
    ds_read_b64_tr_b16 v[134:135], v209 offset:50176
    ds_read_b64_tr_b16 a[132:133], v230 offset:0
    ds_read_b64_tr_b16 a[134:135], v230 offset:1024
    v_mfma_f32_32x32x16_bf16 v[96:111], v[152:155], a[92:95], v[96:111]
    ds_read_b64_tr_b16 v[136:137], v210 offset:49152
    ds_read_b64_tr_b16 v[138:139], v210 offset:50176
    s_add_u32 m0, s59, 4096
    s_nop 0
    buffer_load_dwordx4 v247, s[40:43], s29 offen offset:0 sc1 lds
    ds_read_b64_tr_b16 a[136:137], v0 offset:2048
    ds_read_b64_tr_b16 a[138:139], v0 offset:3072
    v_mfma_f32_32x32x16_bf16 v[112:127], v[156:159], a[92:95], v[112:127]
    ds_read_b64_tr_b16 v[140:141], v211 offset:49152
    ds_read_b64_tr_b16 v[142:143], v211 offset:50176
    ds_read_b64_tr_b16 a[140:141], v230 offset:2048
    ds_read_b64_tr_b16 a[142:143], v230 offset:3072
    s_waitcnt lgkmcnt(14)
    v_mfma_f32_32x32x16_bf16 v[64:79], v[128:131], a[96:99], v[64:79]
    ds_read_b64_tr_b16 v[144:145], v208 offset:53248
    ds_read_b64_tr_b16 v[146:147], v208 offset:54272
    buffer_load_dwordx4 v247, s[40:43], s29 offen offset:1024 sc1 lds
    ds_read_b64_tr_b16 a[144:145], v0 offset:16384
    ds_read_b64_tr_b16 a[146:147], v0 offset:17408
    s_waitcnt lgkmcnt(14)
    v_mfma_f32_32x32x16_bf16 v[80:95], v[132:135], a[96:99], v[80:95]
    ds_read_b64_tr_b16 v[148:149], v209 offset:53248
    ds_read_b64_tr_b16 v[150:151], v209 offset:54272
    ds_read_b64_tr_b16 a[148:149], v230 offset:16384
    ds_read_b64_tr_b16 a[150:151], v230 offset:17408
    s_waitcnt lgkmcnt(14)
    v_mfma_f32_32x32x16_bf16 v[96:111], v[136:139], a[96:99], v[96:111]
    ds_read_b64_tr_b16 v[152:153], v210 offset:53248
    ds_read_b64_tr_b16 v[154:155], v210 offset:54272
    buffer_load_dwordx4 v248, s[40:43], s29 offen offset:2048 sc1 lds
    ds_read_b64_tr_b16 a[152:153], v0 offset:18432
    ds_read_b64_tr_b16 a[154:155], v0 offset:19456
    s_waitcnt lgkmcnt(14)
    v_mfma_f32_32x32x16_bf16 v[112:127], v[140:143], a[96:99], v[112:127]
    ds_read_b64_tr_b16 v[156:157], v211 offset:53248
    ds_read_b64_tr_b16 v[158:159], v211 offset:54272
    ds_read_b64_tr_b16 a[156:157], v230 offset:18432
    ds_read_b64_tr_b16 a[158:159], v230 offset:19456
    s_waitcnt lgkmcnt(14)
    v_mfma_f32_32x32x16_bf16 v[64:79], v[144:147], a[100:103], v[64:79]
    ds_read_b64_tr_b16 v[128:129], v208 offset:57344
    ds_read_b64_tr_b16 v[130:131], v208 offset:58368
    buffer_load_dwordx4 v249, s[40:43], s29 offen offset:3072 sc1 lds
    s_waitcnt vmcnt(8)
    ds_read_b64_tr_b16 a[160:161], v0 offset:32768
    ds_read_b64_tr_b16 a[162:163], v0 offset:33792
    s_waitcnt lgkmcnt(14)
    v_mfma_f32_32x32x16_bf16 v[80:95], v[148:151], a[100:103], v[80:95]
    ds_read_b64_tr_b16 v[132:133], v209 offset:57344
    ds_read_b64_tr_b16 v[134:135], v209 offset:58368
    ds_read_b64_tr_b16 a[164:165], v230 offset:32768
    ds_read_b64_tr_b16 a[166:167], v230 offset:33792
    s_waitcnt lgkmcnt(14)
    v_mfma_f32_32x32x16_bf16 v[96:111], v[152:155], a[100:103], v[96:111]
    ds_read_b64_tr_b16 v[136:137], v210 offset:57344
    ds_read_b64_tr_b16 v[138:139], v210 offset:58368
    ds_read_b64_tr_b16 a[168:169], v0 offset:34816
    ds_read_b64_tr_b16 a[170:171], v0 offset:35840
    s_waitcnt lgkmcnt(14)
    v_mfma_f32_32x32x16_bf16 v[112:127], v[156:159], a[100:103], v[112:127]
    ds_read_b64_tr_b16 v[140:141], v211 offset:57344
    ds_read_b64_tr_b16 v[142:143], v211 offset:58368
    s_add_u32 m0, s59, 8192
    s_nop 0
    buffer_load_dwordx4 v247, s[40:43], s30 offen offset:0 sc1 lds
    ds_read_b64_tr_b16 a[172:173], v230 offset:34816
    ds_read_b64_tr_b16 a[174:175], v230 offset:35840
    s_waitcnt lgkmcnt(14)
    v_mfma_f32_32x32x16_bf16 v[64:79], v[128:131], a[104:107], v[64:79]
    ds_read_b64_tr_b16 v[144:145], v208 offset:61440
    ds_read_b64_tr_b16 v[146:147], v208 offset:62464
    ds_read_b64_tr_b16 v[148:149], v209 offset:61440
    buffer_load_dwordx4 v247, s[40:43], s30 offen offset:1024 sc1 lds
    s_waitcnt lgkmcnt(13)
    v_mfma_f32_32x32x16_bf16 v[80:95], v[132:135], a[104:107], v[80:95]
    ds_read_b64_tr_b16 v[150:151], v209 offset:62464
    ds_read_b64_tr_b16 v[152:153], v210 offset:61440
    ds_read_b64_tr_b16 v[154:155], v210 offset:62464
    s_waitcnt lgkmcnt(12)
    v_mfma_f32_32x32x16_bf16 v[96:111], v[136:139], a[104:107], v[96:111]
    ds_read_b64_tr_b16 v[156:157], v211 offset:61440
    ds_read_b64_tr_b16 v[158:159], v211 offset:62464
    buffer_load_dwordx4 v248, s[40:43], s30 offen offset:2048 sc1 lds
    s_waitcnt lgkmcnt(10)
    v_mfma_f32_32x32x16_bf16 v[112:127], v[140:143], a[104:107], v[112:127]
    buffer_load_dwordx4 v249, s[40:43], s30 offen offset:3072 sc1 lds
    s_waitcnt lgkmcnt(6)
    v_mfma_f32_32x32x16_bf16 v[64:79], v[144:147], a[108:111], v[64:79]
    s_waitcnt lgkmcnt(4)
    v_mfma_f32_32x32x16_bf16 v[80:95], v[148:151], a[108:111], v[80:95]
    buffer_load_dwordx4 v[16:19], v2, s[40:43], s31 offen offset:0 sc1
    s_waitcnt lgkmcnt(2)
    v_mfma_f32_32x32x16_bf16 v[96:111], v[152:155], a[108:111], v[96:111]
    buffer_load_dwordx4 v[20:23], v2, s[40:43], s31 offen offset:1024 sc1
    s_waitcnt lgkmcnt(0)
    v_mfma_f32_32x32x16_bf16 v[112:127], v[156:159], a[108:111], v[112:127]
    s_waitcnt lgkmcnt(0)
    s_barrier
    v_lshrrev_b32 v11, 5, v1
    v_mul_u32_u24 v11, 144384, v11
    v_lshl_add_u32 v11, v1, 7, v11
    s_lshl_b32 s56, s99, 12
    v_add_u32 v201, s56, v11
    v_add_u32 v202, 0x20000, v232
    v_add_u32 v234, 0x20000, v233
    v_and_b32 v12, 31, v1
    v_lshlrev_b32 v12, 2, v12
    s_lshl_b32 s58, s15, 7
    s_add_u32 s58, s58, 16384
    buffer_load_dword v254, v12, s[40:43], s58 offen sc1
    s_and_b32 s57, s3, 1
    s_lshl_b32 s56, s98, 8
    s_add_u32 s56, s56, 16384
    s_lshl_b32 s58, s57, 7
    s_xor_b32 s59, s58, 128
    s_add_u32 s58, s58, s56
    s_add_u32 s59, s59, s56
    s_nop 0
    buffer_load_dword v222, v12, s[40:43], s59 offen sc1
    buffer_load_dword v223, v12, s[40:43], s58 offen sc1
    s_add_u32 m0, s23, 49152
    s_add_u32 s55, s55, 28672
    buffer_load_dwordx4 v216, s[48:51], s55 offen offset:0 lds
    buffer_load_dwordx4 v217, s[48:51], s55 offen offset:1024 lds
    v_pk_mul_f32 v[160:161], v[64:65], v[64:65]
    v_pk_mul_f32 v[162:163], v[66:67], v[66:67]
    v_pk_mul_f32 v[164:165], v[68:69], v[68:69]
    v_pk_mul_f32 v[166:167], v[70:71], v[70:71]
    buffer_load_dwordx4 v218, s[48:51], s55 offen offset:2048 lds
    v_pk_mul_f32 v[168:169], v[72:73], v[72:73]
    v_pk_mul_f32 v[170:171], v[74:75], v[74:75]
    v_pk_mul_f32 v[172:173], v[76:77], v[76:77]
    v_pk_mul_f32 v[174:175], v[78:79], v[78:79]
    v_pk_fma_f32 v[160:161], v[160:161], v[212:213], v[214:215] op_sel_hi:[1,0,0]
    v_pk_fma_f32 v[162:163], v[162:163], v[212:213], v[214:215] op_sel_hi:[1,0,0]
    v_pk_fma_f32 v[164:165], v[164:165], v[212:213], v[214:215] op_sel_hi:[1,0,0]
    v_pk_fma_f32 v[166:167], v[166:167], v[212:213], v[214:215] op_sel_hi:[1,0,0]
    v_pk_fma_f32 v[168:169], v[168:169], v[212:213], v[214:215] op_sel_hi:[1,0,0]
    v_pk_fma_f32 v[170:171], v[170:171], v[212:213], v[214:215] op_sel_hi:[1,0,0]
    v_pk_fma_f32 v[172:173], v[172:173], v[212:213], v[214:215] op_sel_hi:[1,0,0]
    v_pk_fma_f32 v[174:175], v[174:175], v[212:213], v[214:215] op_sel_hi:[1,0,0]
    buffer_load_dwordx4 v219, s[48:51], s55 offen offset:3072 lds
    v_pk_mul_f32 v[160:161], v[160:161], v[64:65]
    v_pk_mul_f32 v[162:163], v[162:163], v[66:67]
    v_pk_mul_f32 v[164:165], v[164:165], v[68:69]
    v_pk_mul_f32 v[166:167], v[166:167], v[70:71]
    v_pk_mul_f32 v[168:169], v[168:169], v[72:73]
    v_pk_mul_f32 v[170:171], v[170:171], v[74:75]
    v_pk_mul_f32 v[172:173], v[172:173], v[76:77]
    v_pk_mul_f32 v[174:175], v[174:175], v[78:79]
    v_exp_f32 v160, v160
    v_exp_f32 v161, v161
    v_exp_f32 v162, v162
    v_exp_f32 v163, v163
    s_add_u32 m0, s23, 65536
    s_add_u32 s55, s55, 28672
    buffer_load_dwordx4 v216, s[48:51], s55 offen offset:0 lds
    v_exp_f32 v164, v164
    v_exp_f32 v165, v165
    v_exp_f32 v166, v166
    v_exp_f32 v167, v167
    v_exp_f32 v168, v168
    v_exp_f32 v169, v169
    v_exp_f32 v170, v170
    v_exp_f32 v171, v171
    buffer_load_dwordx4 v217, s[48:51], s55 offen offset:1024 lds
    v_exp_f32 v172, v172
    v_exp_f32 v173, v173
    v_exp_f32 v174, v174
    v_exp_f32 v175, v175
    buffer_load_dwordx4 v218, s[48:51], s55 offen offset:2048 lds
    v_pk_add_f32 v[160:161], v[160:161], 1.0 op_sel_hi:[1,0]
    v_pk_add_f32 v[162:163], v[162:163], 1.0 op_sel_hi:[1,0]
    v_pk_add_f32 v[164:165], v[164:165], 1.0 op_sel_hi:[1,0]
    v_pk_add_f32 v[166:167], v[166:167], 1.0 op_sel_hi:[1,0]
    v_pk_add_f32 v[168:169], v[168:169], 1.0 op_sel_hi:[1,0]
    v_pk_add_f32 v[170:171], v[170:171], 1.0 op_sel_hi:[1,0]
    v_pk_add_f32 v[172:173], v[172:173], 1.0 op_sel_hi:[1,0]
    v_pk_add_f32 v[174:175], v[174:175], 1.0 op_sel_hi:[1,0]
    v_rcp_f32 v160, v160
    v_rcp_f32 v161, v161
    v_rcp_f32 v162, v162
    v_rcp_f32 v163, v163
    buffer_load_dwordx4 v219, s[48:51], s55 offen offset:3072 lds
    v_rcp_f32 v164, v164
    v_rcp_f32 v165, v165
    v_rcp_f32 v166, v166
    v_rcp_f32 v167, v167
    v_rcp_f32 v168, v168
    v_rcp_f32 v169, v169
    v_rcp_f32 v170, v170
    v_rcp_f32 v171, v171
    s_add_u32 m0, s23, 81920
    s_add_u32 s55, s55, 28672
    buffer_load_dwordx4 v216, s[48:51], s55 offen offset:0 lds
    v_rcp_f32 v172, v172
    v_rcp_f32 v173, v173
    v_rcp_f32 v174, v174
    v_rcp_f32 v175, v175
    v_pk_mul_f32 v[160:161], v[160:161], v[64:65]
    v_pk_mul_f32 v[162:163], v[162:163], v[66:67]
    v_pk_mul_f32 v[164:165], v[164:165], v[68:69]
    v_pk_mul_f32 v[166:167], v[166:167], v[70:71]
    buffer_load_dwordx4 v217, s[48:51], s55 offen offset:1024 lds
    v_pk_mul_f32 v[168:169], v[168:169], v[72:73]
    v_pk_mul_f32 v[170:171], v[170:171], v[74:75]
    v_pk_mul_f32 v[172:173], v[172:173], v[76:77]
    v_pk_mul_f32 v[174:175], v[174:175], v[78:79]
    v_cvt_pk_bf16_f32 v192, v160, v161
    v_cvt_pk_bf16_f32 v193, v162, v163
    v_cvt_pk_bf16_f32 v194, v164, v165
    v_cvt_pk_bf16_f32 v195, v166, v167
    v_cvt_pk_bf16_f32 v196, v168, v169
    v_cvt_pk_bf16_f32 v197, v170, v171
    v_cvt_pk_bf16_f32 v198, v172, v173
    v_cvt_pk_bf16_f32 v199, v174, v175
    buffer_load_dwordx4 v218, s[48:51], s55 offen offset:2048 lds
    v_pk_mul_f32 v[176:177], v[80:81], v[80:81]
    v_pk_mul_f32 v[178:179], v[82:83], v[82:83]
    v_pk_mul_f32 v[180:181], v[84:85], v[84:85]
    v_pk_mul_f32 v[182:183], v[86:87], v[86:87]
    v_pk_mul_f32 v[184:185], v[88:89], v[88:89]
    v_pk_mul_f32 v[186:187], v[90:91], v[90:91]
    v_pk_mul_f32 v[188:189], v[92:93], v[92:93]
    v_pk_mul_f32 v[190:191], v[94:95], v[94:95]
    v_pk_fma_f32 v[176:177], v[176:177], v[212:213], v[214:215] op_sel_hi:[1,0,0]
    v_pk_fma_f32 v[178:179], v[178:179], v[212:213], v[214:215] op_sel_hi:[1,0,0]
    v_pk_fma_f32 v[180:181], v[180:181], v[212:213], v[214:215] op_sel_hi:[1,0,0]
    v_pk_fma_f32 v[182:183], v[182:183], v[212:213], v[214:215] op_sel_hi:[1,0,0]
    buffer_load_dwordx4 v219, s[48:51], s55 offen offset:3072 lds
    v_pk_fma_f32 v[184:185], v[184:185], v[212:213], v[214:215] op_sel_hi:[1,0,0]
    v_pk_fma_f32 v[186:187], v[186:187], v[212:213], v[214:215] op_sel_hi:[1,0,0]
    v_pk_fma_f32 v[188:189], v[188:189], v[212:213], v[214:215] op_sel_hi:[1,0,0]
    v_pk_fma_f32 v[190:191], v[190:191], v[212:213], v[214:215] op_sel_hi:[1,0,0]
    v_pk_mul_f32 v[176:177], v[176:177], v[80:81]
    v_pk_mul_f32 v[178:179], v[178:179], v[82:83]
    v_pk_mul_f32 v[180:181], v[180:181], v[84:85]
    v_pk_mul_f32 v[182:183], v[182:183], v[86:87]
    v_pk_mul_f32 v[184:185], v[184:185], v[88:89]
    v_pk_mul_f32 v[186:187], v[186:187], v[90:91]
    v_pk_mul_f32 v[188:189], v[188:189], v[92:93]
    v_pk_mul_f32 v[190:191], v[190:191], v[94:95]
    s_add_u32 m0, s23, 98304
    s_add_u32 s55, s55, 28672
    buffer_load_dwordx4 v216, s[48:51], s55 offen offset:0 lds
    v_exp_f32 v176, v176
    v_exp_f32 v177, v177
    v_exp_f32 v178, v178
    v_exp_f32 v179, v179
    v_exp_f32 v180, v180
    v_exp_f32 v181, v181
    v_exp_f32 v182, v182
    v_exp_f32 v183, v183
    buffer_load_dwordx4 v217, s[48:51], s55 offen offset:1024 lds
    v_exp_f32 v184, v184
    v_exp_f32 v185, v185
    v_exp_f32 v186, v186
    v_exp_f32 v187, v187
    v_exp_f32 v188, v188
    v_exp_f32 v189, v189
    v_exp_f32 v190, v190
    v_exp_f32 v191, v191
    buffer_load_dwordx4 v218, s[48:51], s55 offen offset:2048 lds
    v_pk_add_f32 v[176:177], v[176:177], 1.0 op_sel_hi:[1,0]
    v_pk_add_f32 v[178:179], v[178:179], 1.0 op_sel_hi:[1,0]
    v_pk_add_f32 v[180:181], v[180:181], 1.0 op_sel_hi:[1,0]
    v_pk_add_f32 v[182:183], v[182:183], 1.0 op_sel_hi:[1,0]
    v_pk_add_f32 v[184:185], v[184:185], 1.0 op_sel_hi:[1,0]
    v_pk_add_f32 v[186:187], v[186:187], 1.0 op_sel_hi:[1,0]
    v_pk_add_f32 v[188:189], v[188:189], 1.0 op_sel_hi:[1,0]
    v_pk_add_f32 v[190:191], v[190:191], 1.0 op_sel_hi:[1,0]
    v_rcp_f32 v176, v176
    v_rcp_f32 v177, v177
    v_rcp_f32 v178, v178
    v_rcp_f32 v179, v179
    buffer_load_dwordx4 v219, s[48:51], s55 offen offset:3072 lds
    v_rcp_f32 v180, v180
    v_rcp_f32 v181, v181
    v_rcp_f32 v182, v182
    v_rcp_f32 v183, v183
    s_add_u32 m0, s23, 114688
    s_add_u32 s55, s55, 28672
    buffer_load_dwordx4 v216, s[48:51], s55 offen offset:0 lds
    v_rcp_f32 v184, v184
    v_rcp_f32 v185, v185
    v_rcp_f32 v186, v186
    v_rcp_f32 v187, v187
    v_rcp_f32 v188, v188
    v_rcp_f32 v189, v189
    v_rcp_f32 v190, v190
    v_rcp_f32 v191, v191
    buffer_load_dwordx4 v217, s[48:51], s55 offen offset:1024 lds
    v_pk_mul_f32 v[176:177], v[176:177], v[80:81]
    v_pk_mul_f32 v[178:179], v[178:179], v[82:83]
    v_pk_mul_f32 v[180:181], v[180:181], v[84:85]
    v_pk_mul_f32 v[182:183], v[182:183], v[86:87]
    v_pk_mul_f32 v[184:185], v[184:185], v[88:89]
    v_pk_mul_f32 v[186:187], v[186:187], v[90:91]
    v_pk_mul_f32 v[188:189], v[188:189], v[92:93]
    v_pk_mul_f32 v[190:191], v[190:191], v[94:95]
    v_cvt_pk_bf16_f32 v204, v176, v177
    v_cvt_pk_bf16_f32 v205, v178, v179
    v_cvt_pk_bf16_f32 v206, v180, v181
    v_cvt_pk_bf16_f32 v207, v182, v183
    buffer_load_dwordx4 v218, s[48:51], s55 offen offset:2048 lds
    v_cvt_pk_bf16_f32 v208, v184, v185
    v_cvt_pk_bf16_f32 v209, v186, v187
    v_cvt_pk_bf16_f32 v210, v188, v189
    v_cvt_pk_bf16_f32 v211, v190, v191
    buffer_store_dwordx4 v[192:195], v2, s[40:43], s62 offen offset:0 sc1
    buffer_store_dwordx4 v[196:199], v2, s[40:43], s62 offen offset:1024 sc1
    buffer_store_dwordx4 v[204:207], v2, s[40:43], s62 offen offset:2048 sc1
    buffer_store_dwordx4 v[208:211], v2, s[40:43], s62 offen offset:3072 sc1
    s_waitcnt vmcnt(28)
    ds_write_b16 v250, v251 offset:0
    ds_write_b16 v250, v252 offset:4096
    ds_write_b16 v250, v253 offset:8192
    s_cmp_eq_u32 s101, 0
    s_cselect_b32 s56, 0, -1
    s_cselect_b32 s59, -1, 0
    s_mov_b32 s57, 0
    s_mov_b32 s58, 0
    v_mov_b32 v11, 0x3f80
    s_waitcnt vmcnt(27)
    v_cndmask_b32_e64 v16, v16, v11, s[56:57]
    v_cndmask_b32_e64 v17, v17, 0, s[56:57]
    s_waitcnt vmcnt(26)
    v_cndmask_b32_e64 v22, v22, v11, s[58:59]
    v_cndmask_b32_e64 v23, v23, 0, s[58:59]
    buffer_load_dwordx4 v219, s[48:51], s55 offen offset:3072 lds
    v_pk_mul_f32 v[160:161], v[96:97], v[96:97]
    v_pk_mul_f32 v[162:163], v[98:99], v[98:99]
    v_pk_mul_f32 v[164:165], v[100:101], v[100:101]
    v_pk_mul_f32 v[166:167], v[102:103], v[102:103]
    s_add_u32 m0, s23, 131072
    s_add_u32 s55, s55, 28672
    buffer_load_dwordx4 v216, s[48:51], s55 offen offset:0 lds
    v_pk_mul_f32 v[168:169], v[104:105], v[104:105]
    v_pk_mul_f32 v[170:171], v[106:107], v[106:107]
    v_pk_mul_f32 v[172:173], v[108:109], v[108:109]
    v_pk_mul_f32 v[174:175], v[110:111], v[110:111]
    v_pk_fma_f32 v[160:161], v[160:161], v[212:213], v[214:215] op_sel_hi:[1,0,0]
    v_pk_fma_f32 v[162:163], v[162:163], v[212:213], v[214:215] op_sel_hi:[1,0,0]
    v_pk_fma_f32 v[164:165], v[164:165], v[212:213], v[214:215] op_sel_hi:[1,0,0]
    v_pk_fma_f32 v[166:167], v[166:167], v[212:213], v[214:215] op_sel_hi:[1,0,0]
    v_pk_fma_f32 v[168:169], v[168:169], v[212:213], v[214:215] op_sel_hi:[1,0,0]
    v_pk_fma_f32 v[170:171], v[170:171], v[212:213], v[214:215] op_sel_hi:[1,0,0]
    v_pk_fma_f32 v[172:173], v[172:173], v[212:213], v[214:215] op_sel_hi:[1,0,0]
    v_pk_fma_f32 v[174:175], v[174:175], v[212:213], v[214:215] op_sel_hi:[1,0,0]
    buffer_load_dwordx4 v217, s[48:51], s55 offen offset:1024 lds
    v_pk_mul_f32 v[160:161], v[160:161], v[96:97]
    v_pk_mul_f32 v[162:163], v[162:163], v[98:99]
    v_pk_mul_f32 v[164:165], v[164:165], v[100:101]
    v_pk_mul_f32 v[166:167], v[166:167], v[102:103]
    v_pk_mul_f32 v[168:169], v[168:169], v[104:105]
    v_pk_mul_f32 v[170:171], v[170:171], v[106:107]
    v_pk_mul_f32 v[172:173], v[172:173], v[108:109]
    v_pk_mul_f32 v[174:175], v[174:175], v[110:111]
    v_exp_f32 v160, v160
    v_exp_f32 v161, v161
    v_exp_f32 v162, v162
    v_exp_f32 v163, v163
    buffer_load_dwordx4 v218, s[48:51], s55 offen offset:2048 lds
    v_exp_f32 v164, v164
    v_exp_f32 v165, v165
    v_exp_f32 v166, v166
    v_exp_f32 v167, v167
    v_exp_f32 v168, v168
    v_exp_f32 v169, v169
    v_exp_f32 v170, v170
    v_exp_f32 v171, v171
    buffer_load_dwordx4 v219, s[48:51], s55 offen offset:3072 lds
    v_exp_f32 v172, v172
    v_exp_f32 v173, v173
    v_exp_f32 v174, v174
    v_exp_f32 v175, v175
    v_pk_add_f32 v[160:161], v[160:161], 1.0 op_sel_hi:[1,0]
    v_pk_add_f32 v[162:163], v[162:163], 1.0 op_sel_hi:[1,0]
    v_pk_add_f32 v[164:165], v[164:165], 1.0 op_sel_hi:[1,0]
    v_pk_add_f32 v[166:167], v[166:167], 1.0 op_sel_hi:[1,0]
    v_pk_add_f32 v[168:169], v[168:169], 1.0 op_sel_hi:[1,0]
    v_pk_add_f32 v[170:171], v[170:171], 1.0 op_sel_hi:[1,0]
    v_pk_add_f32 v[172:173], v[172:173], 1.0 op_sel_hi:[1,0]
    v_pk_add_f32 v[174:175], v[174:175], 1.0 op_sel_hi:[1,0]
    v_rcp_f32 v160, v160
    v_rcp_f32 v161, v161
    v_rcp_f32 v162, v162
    v_rcp_f32 v163, v163
    v_rcp_f32 v164, v164
    v_rcp_f32 v165, v165
    v_rcp_f32 v166, v166
    v_rcp_f32 v167, v167
    v_rcp_f32 v168, v168
    v_rcp_f32 v169, v169
    v_rcp_f32 v170, v170
    v_rcp_f32 v171, v171
    v_rcp_f32 v172, v172
    v_rcp_f32 v173, v173
    v_rcp_f32 v174, v174
    v_rcp_f32 v175, v175
    v_pk_mul_f32 v[160:161], v[160:161], v[96:97]
    v_pk_mul_f32 v[162:163], v[162:163], v[98:99]
    v_pk_mul_f32 v[164:165], v[164:165], v[100:101]
    v_pk_mul_f32 v[166:167], v[166:167], v[102:103]
    v_pk_mul_f32 v[168:169], v[168:169], v[104:105]
    v_pk_mul_f32 v[170:171], v[170:171], v[106:107]
    v_pk_mul_f32 v[172:173], v[172:173], v[108:109]
    v_pk_mul_f32 v[174:175], v[174:175], v[110:111]
    v_cvt_pk_bf16_f32 v160, v160, v161
    v_cvt_pk_bf16_f32 v161, v162, v163
    v_cvt_pk_bf16_f32 v162, v164, v165
    v_cvt_pk_bf16_f32 v163, v166, v167
    v_cvt_pk_bf16_f32 v164, v168, v169
    v_cvt_pk_bf16_f32 v165, v170, v171
    v_cvt_pk_bf16_f32 v166, v172, v173
    v_cvt_pk_bf16_f32 v167, v174, v175
    buffer_store_dwordx4 v[160:163], v3, s[40:43], s62 offen offset:0 sc1
    buffer_store_dwordx4 v[164:167], v3, s[40:43], s62 offen offset:1024 sc1
    v_pk_mul_f32 v[176:177], v[112:113], v[112:113]
    v_pk_mul_f32 v[178:179], v[114:115], v[114:115]
    v_pk_mul_f32 v[180:181], v[116:117], v[116:117]
    v_pk_mul_f32 v[182:183], v[118:119], v[118:119]
    v_pk_mul_f32 v[184:185], v[120:121], v[120:121]
    v_pk_mul_f32 v[186:187], v[122:123], v[122:123]
    v_pk_mul_f32 v[188:189], v[124:125], v[124:125]
    v_pk_mul_f32 v[190:191], v[126:127], v[126:127]
    v_pk_fma_f32 v[176:177], v[176:177], v[212:213], v[214:215] op_sel_hi:[1,0,0]
    v_pk_fma_f32 v[178:179], v[178:179], v[212:213], v[214:215] op_sel_hi:[1,0,0]
    v_pk_fma_f32 v[180:181], v[180:181], v[212:213], v[214:215] op_sel_hi:[1,0,0]
    v_pk_fma_f32 v[182:183], v[182:183], v[212:213], v[214:215] op_sel_hi:[1,0,0]
    v_pk_fma_f32 v[184:185], v[184:185], v[212:213], v[214:215] op_sel_hi:[1,0,0]
    v_pk_fma_f32 v[186:187], v[186:187], v[212:213], v[214:215] op_sel_hi:[1,0,0]
    v_pk_fma_f32 v[188:189], v[188:189], v[212:213], v[214:215] op_sel_hi:[1,0,0]
    v_pk_fma_f32 v[190:191], v[190:191], v[212:213], v[214:215] op_sel_hi:[1,0,0]
    v_pk_mul_f32 v[176:177], v[176:177], v[112:113]
    v_pk_mul_f32 v[178:179], v[178:179], v[114:115]
    v_pk_mul_f32 v[180:181], v[180:181], v[116:117]
    v_pk_mul_f32 v[182:183], v[182:183], v[118:119]
    v_pk_mul_f32 v[184:185], v[184:185], v[120:121]
    v_pk_mul_f32 v[186:187], v[186:187], v[122:123]
    v_pk_mul_f32 v[188:189], v[188:189], v[124:125]
    v_pk_mul_f32 v[190:191], v[190:191], v[126:127]
    v_exp_f32 v176, v176
    v_exp_f32 v177, v177
    v_exp_f32 v178, v178
    v_exp_f32 v179, v179
    v_exp_f32 v180, v180
    v_exp_f32 v181, v181
    v_exp_f32 v182, v182
    v_exp_f32 v183, v183
    v_exp_f32 v184, v184
    v_exp_f32 v185, v185
    v_exp_f32 v186, v186
    v_exp_f32 v187, v187
    v_exp_f32 v188, v188
    v_exp_f32 v189, v189
    v_exp_f32 v190, v190
    v_exp_f32 v191, v191
    v_pk_add_f32 v[176:177], v[176:177], 1.0 op_sel_hi:[1,0]
    v_pk_add_f32 v[178:179], v[178:179], 1.0 op_sel_hi:[1,0]
    v_pk_add_f32 v[180:181], v[180:181], 1.0 op_sel_hi:[1,0]
    v_pk_add_f32 v[182:183], v[182:183], 1.0 op_sel_hi:[1,0]
    v_pk_add_f32 v[184:185], v[184:185], 1.0 op_sel_hi:[1,0]
    v_pk_add_f32 v[186:187], v[186:187], 1.0 op_sel_hi:[1,0]
    v_pk_add_f32 v[188:189], v[188:189], 1.0 op_sel_hi:[1,0]
    v_pk_add_f32 v[190:191], v[190:191], 1.0 op_sel_hi:[1,0]
    v_rcp_f32 v176, v176
    v_rcp_f32 v177, v177
    v_rcp_f32 v178, v178
    v_rcp_f32 v179, v179
    v_rcp_f32 v180, v180
    v_rcp_f32 v181, v181
    v_rcp_f32 v182, v182
    v_rcp_f32 v183, v183
    v_rcp_f32 v184, v184
    v_rcp_f32 v185, v185
    v_rcp_f32 v186, v186
    v_rcp_f32 v187, v187
    v_rcp_f32 v188, v188
    v_rcp_f32 v189, v189
    v_rcp_f32 v190, v190
    v_rcp_f32 v191, v191
    v_pk_mul_f32 v[176:177], v[176:177], v[112:113]
    v_pk_mul_f32 v[178:179], v[178:179], v[114:115]
    v_pk_mul_f32 v[180:181], v[180:181], v[116:117]
    v_pk_mul_f32 v[182:183], v[182:183], v[118:119]
    v_pk_mul_f32 v[184:185], v[184:185], v[120:121]
    v_pk_mul_f32 v[186:187], v[186:187], v[122:123]
    v_pk_mul_f32 v[188:189], v[188:189], v[124:125]
    v_pk_mul_f32 v[190:191], v[190:191], v[126:127]
    v_cvt_pk_bf16_f32 v176, v176, v177
    v_cvt_pk_bf16_f32 v177, v178, v179
    v_cvt_pk_bf16_f32 v178, v180, v181
    v_cvt_pk_bf16_f32 v179, v182, v183
    v_cvt_pk_bf16_f32 v180, v184, v185
    v_cvt_pk_bf16_f32 v181, v186, v187
    v_cvt_pk_bf16_f32 v182, v188, v189
    v_cvt_pk_bf16_f32 v183, v190, v191
    buffer_store_dwordx4 v[176:179], v3, s[40:43], s62 offen offset:2048 sc1
    buffer_store_dwordx4 v[180:183], v3, s[40:43], s62 offen offset:3072 sc1
    s_waitcnt lgkmcnt(0)
    s_barrier
    ds_read_b128 v[24:27], v244 offset:0
    ds_read_b128 v[28:31], v244 offset:1024
    ds_read_b128 v[32:35], v244 offset:32768
    ds_read_b128 v[36:39], v244 offset:33792
    s_waitcnt lgkmcnt(3)
    v_mfma_f32_32x32x16_bf16 v[56:71], v[24:27], v[16:19], 0
    s_waitcnt vmcnt(28)
    ds_read_b64_tr_b16 a[176:177], v232 offset:49152
    ds_read_b64_tr_b16 a[178:179], v232 offset:50176
    ds_read_b64_tr_b16 a[180:181], v233 offset:49152
    ds_read_b64_tr_b16 a[182:183], v233 offset:50176
    s_waitcnt lgkmcnt(6)
    v_mfma_f32_32x32x16_bf16 v[56:71], v[28:31], v[20:23], v[56:71]
    s_nop 0
    ds_read_b128 v[24:27], v244 offset:4096
    ds_read_b128 v[28:31], v244 offset:5120
    ds_read_b64_tr_b16 a[184:185], v232 offset:51200
    ds_read_b64_tr_b16 a[186:187], v232 offset:52224
    ds_read_b64_tr_b16 a[188:189], v233 offset:51200
    ds_read_b64_tr_b16 a[190:191], v233 offset:52224
    s_waitcnt lgkmcnt(11)
    v_mfma_f32_32x32x16_bf16 v[72:87], v[32:35], v[16:19], 0
    s_waitcnt vmcnt(24)
    ds_read_b64_tr_b16 a[192:193], v0 offset:0
    ds_read_b64_tr_b16 a[194:195], v0 offset:1024
    ds_read_b64_tr_b16 a[196:197], v230 offset:0
    ds_read_b64_tr_b16 a[198:199], v230 offset:1024
    s_waitcnt lgkmcnt(14)
    v_mfma_f32_32x32x16_bf16 v[72:87], v[36:39], v[20:23], v[72:87]
    s_nop 0
    ds_read_b128 v[32:35], v244 offset:8192
    ds_read_b128 v[36:39], v244 offset:9216
    ds_read_b64_tr_b16 a[200:201], v0 offset:2048
    ds_read_b64_tr_b16 a[202:203], v0 offset:3072
    ds_read_b64_tr_b16 a[204:205], v230 offset:2048
    ds_read_b64_tr_b16 a[206:207], v230 offset:3072
    s_waitcnt lgkmcnt(15)
    v_mfma_f32_32x32x16_bf16 v[88:103], v[24:27], v[16:19], 0
    s_waitcnt vmcnt(20)
    ds_read_b64_tr_b16 a[208:209], v0 offset:16384
    ds_read_b64_tr_b16 a[210:211], v0 offset:17408
    s_add_u32 m0, s23, 147456
    s_add_u32 s55, s55, 28672
    buffer_load_dwordx4 v216, s[48:51], s55 offen offset:0 lds
    ds_read_b64_tr_b16 a[212:213], v230 offset:16384
    ds_read_b64_tr_b16 a[214:215], v230 offset:17408
    buffer_load_dwordx4 v217, s[48:51], s55 offen offset:1024 lds
    buffer_load_dwordx4 v218, s[48:51], s55 offen offset:2048 lds
    s_waitcnt lgkmcnt(15)
    v_mfma_f32_32x32x16_bf16 v[88:103], v[28:31], v[20:23], v[88:103]
    s_nop 0
    ds_read_b128 v[24:27], v244 offset:12288
    ds_read_b128 v[28:31], v244 offset:13312
    ds_read_b64_tr_b16 a[216:217], v0 offset:18432
    ds_read_b64_tr_b16 a[218:219], v0 offset:19456
    ds_read_b64_tr_b16 a[220:221], v230 offset:18432
    ds_read_b64_tr_b16 a[222:223], v230 offset:19456
    s_waitcnt lgkmcnt(15)
    v_mfma_f32_32x32x16_bf16 v[120:135], v[32:35], v[16:19], 0
    s_waitcnt vmcnt(19)
    ds_read_b64_tr_b16 a[224:225], v0 offset:32768
    ds_read_b64_tr_b16 a[226:227], v0 offset:33792
    buffer_load_dwordx4 v219, s[48:51], s55 offen offset:3072 lds
    ds_read_b64_tr_b16 a[228:229], v230 offset:32768
    ds_read_b64_tr_b16 a[230:231], v230 offset:33792
    v_cndmask_b32_e64 v72, v56, v72, s[64:65]
    v_cndmask_b32_e64 v73, v57, v73, s[66:67]
    v_cndmask_b32_e64 v74, v58, v74, s[68:69]
    v_cndmask_b32_e64 v75, v59, v75, s[70:71]
    v_cndmask_b32_e64 v76, v60, v76, s[72:73]
    v_cndmask_b32_e64 v77, v61, v77, s[74:75]
    v_cndmask_b32_e64 v78, v62, v78, s[76:77]
    v_cndmask_b32_e64 v79, v63, v79, s[78:79]
    s_waitcnt lgkmcnt(15)
    v_mfma_f32_32x32x16_bf16 v[120:135], v[36:39], v[20:23], v[120:135]
    s_nop 0
    ds_read_b128 v[32:35], v244 offset:16384
    ds_read_b128 v[36:39], v244 offset:17408
    ds_read_b64_tr_b16 a[232:233], v0 offset:34816
    ds_read_b64_tr_b16 a[234:235], v0 offset:35840
    s_add_u32 m0, s23, 49152
    s_add_u32 s55, s55, 28672
    buffer_load_dwordx4 v216, s[48:51], s55 offen offset:0 lds
    ds_read_b64_tr_b16 a[236:237], v230 offset:34816
    ds_read_b64_tr_b16 a[238:239], v230 offset:35840
    v_cndmask_b32_e64 v80, v64, v80, s[80:81]
    v_cndmask_b32_e64 v81, v65, v81, s[82:83]
    v_cndmask_b32_e64 v82, v66, v82, s[84:85]
    v_cndmask_b32_e64 v83, v67, v83, s[86:87]
    v_cndmask_b32_e64 v84, v68, v84, s[88:89]
    v_cndmask_b32_e64 v85, v69, v85, s[90:91]
    v_cndmask_b32_e64 v86, v70, v86, s[92:93]
    v_cndmask_b32_e64 v87, v71, v87, s[94:95]
    s_waitcnt lgkmcnt(15)
    v_mfma_f32_32x32x16_bf16 v[56:71], v[24:27], v[16:19], 0
    s_waitcnt vmcnt(5)
    buffer_store_dwordx2 v[6:7], v4, s[40:43], s13 offen sc1
    ds_read_b64_tr_b16 a[240:241], v0 offset:49152
    ds_read_b64_tr_b16 a[242:243], v0 offset:50176
    ds_read_b64_tr_b16 a[244:245], v230 offset:49152
    ds_read_b64_tr_b16 a[246:247], v230 offset:50176
    buffer_load_dwordx4 v217, s[48:51], s55 offen offset:1024 lds
    v_max_f32_e64 v5, v72, v73
    v_max3_f32 v5, v74, v75, v5
    v_max3_f32 v5, v76, v77, v5
    v_max3_f32 v5, v78, v79, v5
    v_max3_f32 v5, v80, v81, v5
    v_max3_f32 v5, v82, v83, v5
    v_max3_f32 v5, v84, v85, v5
    v_max3_f32 v5, v86, v87, v5
    s_waitcnt lgkmcnt(15)
    v_mfma_f32_32x32x16_bf16 v[56:71], v[28:31], v[20:23], v[56:71]
    s_nop 0
    ds_read_b128 v[24:27], v244 offset:20480
    ds_read_b128 v[28:31], v244 offset:21504
    ds_read_b64_tr_b16 a[248:249], v0 offset:51200
    ds_read_b64_tr_b16 a[250:251], v0 offset:52224
    buffer_load_dwordx4 v218, s[48:51], s55 offen offset:2048 lds
    ds_read_b64_tr_b16 a[252:253], v230 offset:51200
    ds_read_b64_tr_b16 a[254:255], v230 offset:52224
    v_max3_f32 v5, v88, v89, v5
    v_max3_f32 v5, v90, v91, v5
    v_max3_f32 v5, v92, v93, v5
    v_max3_f32 v5, v94, v95, v5
    v_max3_f32 v5, v96, v97, v5
    v_max3_f32 v5, v98, v99, v5
    v_max3_f32 v5, v100, v101, v5
    v_max3_f32 v5, v102, v103, v5
    s_waitcnt lgkmcnt(15)
    v_mfma_f32_32x32x16_bf16 v[88:103], v[32:35], v[16:19], 0
    s_nop 0
    ds_read_b64_tr_b16 a[0:1], v202 offset:0
    ds_read_b64_tr_b16 a[2:3], v202 offset:1024
    ds_read_b64_tr_b16 a[4:5], v234 offset:0
    ds_read_b64_tr_b16 a[6:7], v234 offset:1024
    buffer_load_dwordx4 v219, s[48:51], s55 offen offset:3072 lds
    v_max3_f32 v5, v120, v121, v5
    v_max3_f32 v5, v122, v123, v5
    v_max3_f32 v5, v124, v125, v5
    v_max3_f32 v5, v126, v127, v5
    s_waitcnt lgkmcnt(15)
    v_mfma_f32_32x32x16_bf16 v[88:103], v[36:39], v[20:23], v[88:103]
    s_nop 0
    ds_read_b128 v[32:35], v244 offset:24576
    ds_read_b128 v[36:39], v244 offset:25600
    ds_read_b64_tr_b16 a[8:9], v202 offset:2048
    ds_read_b64_tr_b16 a[10:11], v202 offset:3072
    ds_read_b64_tr_b16 a[12:13], v234 offset:2048
    ds_read_b64_tr_b16 a[14:15], v234 offset:3072
    v_max3_f32 v5, v128, v129, v5
    v_max3_f32 v5, v130, v131, v5
    v_max3_f32 v5, v132, v133, v5
    v_max3_f32 v5, v134, v135, v5
    s_waitcnt lgkmcnt(15)
    v_mfma_f32_32x32x16_bf16 v[120:135], v[24:27], v[16:19], 0
    s_nop 0
    s_add_u32 m0, s23, 65536
    s_add_u32 s55, s55, 28672
    buffer_load_dwordx4 v216, s[48:51], s55 offen offset:0 lds
    v_max3_f32 v5, v56, v57, v5
    v_max3_f32 v5, v58, v59, v5
    v_max3_f32 v5, v60, v61, v5
    v_max3_f32 v5, v62, v63, v5
    s_waitcnt lgkmcnt(14)
    v_mfma_f32_32x32x16_bf16 v[120:135], v[28:31], v[20:23], v[120:135]
    s_nop 0
    ds_read_b128 v[24:27], v244 offset:28672
    ds_read_b128 v[28:31], v244 offset:29696
    v_max3_f32 v5, v64, v65, v5
    v_max3_f32 v5, v66, v67, v5
    v_max3_f32 v5, v68, v69, v5
    v_max3_f32 v5, v70, v71, v5
    s_waitcnt lgkmcnt(7)
    v_mfma_f32_32x32x16_bf16 v[56:71], v[32:35], v[16:19], 0
    buffer_load_dwordx4 v217, s[48:51], s55 offen offset:1024 lds
    v_max3_f32 v5, v88, v89, v5
    v_max3_f32 v5, v90, v91, v5
    v_max3_f32 v5, v92, v93, v5
    v_max3_f32 v5, v94, v95, v5
    s_waitcnt lgkmcnt(6)
    v_mfma_f32_32x32x16_bf16 v[56:71], v[36:39], v[20:23], v[56:71]
    ds_read_b128 v[32:35], v244 offset:4096
    ds_read_b128 v[36:39], v244 offset:5120
    v_max3_f32 v5, v96, v97, v5
    v_max3_f32 v5, v98, v99, v5
    v_max3_f32 v5, v100, v101, v5
    v_max3_f32 v5, v102, v103, v5
    s_waitcnt lgkmcnt(3)
    v_mfma_f32_32x32x16_bf16 v[88:103], v[24:27], v[16:19], 0
    buffer_load_dwordx4 v218, s[48:51], s55 offen offset:2048 lds
    v_max3_f32 v5, v120, v121, v5
    v_max3_f32 v5, v122, v123, v5
    v_max3_f32 v5, v124, v125, v5
    v_max3_f32 v5, v126, v127, v5
    s_waitcnt lgkmcnt(2)
    v_mfma_f32_32x32x16_bf16 v[88:103], v[28:31], v[20:23], v[88:103]
    ds_read_b128 v[24:27], v244 offset:8192
    ds_read_b128 v[28:31], v244 offset:9216
    ds_read_b64_tr_b16 v[40:41], v245 offset:0
    ds_read_b64_tr_b16 v[42:43], v246 offset:0
    ds_read_b64_tr_b16 v[44:45], v245 offset:256
    ds_read_b64_tr_b16 v[46:47], v246 offset:256
    ds_read_b64_tr_b16 v[48:49], v245 offset:32768
    ds_read_b64_tr_b16 v[50:51], v246 offset:32768
    ds_read_b64_tr_b16 v[52:53], v245 offset:33024
    ds_read_b64_tr_b16 v[54:55], v246 offset:33024
    buffer_load_dwordx4 v219, s[48:51], s55 offen offset:3072 lds
    v_max3_f32 v5, v128, v129, v5
    v_max3_f32 v5, v130, v131, v5
    v_max3_f32 v5, v132, v133, v5
    v_max3_f32 v5, v134, v135, v5
    v_max3_f32 v5, v56, v57, v5
    v_max3_f32 v5, v58, v59, v5
    v_max3_f32 v5, v60, v61, v5
    v_max3_f32 v5, v62, v63, v5
    v_max3_f32 v5, v64, v65, v5
    v_max3_f32 v5, v66, v67, v5
    v_max3_f32 v5, v68, v69, v5
    v_max3_f32 v5, v70, v71, v5
    v_max3_f32 v5, v88, v89, v5
    v_max3_f32 v5, v90, v91, v5
    v_max3_f32 v5, v92, v93, v5
    v_max3_f32 v5, v94, v95, v5
    v_max3_f32 v5, v96, v97, v5
    v_max3_f32 v5, v98, v99, v5
    v_max3_f32 v5, v100, v101, v5
    v_max3_f32 v5, v102, v103, v5
    v_mov_b32 v11, v5
    s_nop 1
    v_permlane32_swap_b32 v5, v11
    v_max_f32 v5, v5, v11
    v_sub_f32 v104, 0, v5
    v_sub_f32 v105, 0, v5
    v_mov_b64 v[106:107], v[104:105]
    v_mov_b64 v[108:109], v[104:105]
    v_mov_b64 v[110:111], v[104:105]
    v_mov_b64 v[112:113], v[104:105]
    v_mov_b64 v[114:115], v[104:105]
    v_mov_b64 v[116:117], v[104:105]
    v_mov_b64 v[118:119], v[104:105]
    s_waitcnt lgkmcnt(11)
    s_nop 0
    v_mfma_f32_32x32x16_bf16 v[56:71], v[32:35], v[16:19], v[104:119]
    s_add_u32 m0, s23, 81920
    s_add_u32 s55, s55, 28672
    buffer_load_dwordx4 v216, s[48:51], s55 offen offset:0 lds
    s_waitcnt vmcnt(10)
    ds_read_b64_tr_b16 a[16:17], v202 offset:16384
    ds_read_b64_tr_b16 a[18:19], v202 offset:17408
    buffer_load_dwordx4 v217, s[48:51], s55 offen offset:1024 lds
    ds_read_b64_tr_b16 a[20:21], v234 offset:16384
    ds_read_b64_tr_b16 a[22:23], v234 offset:17408
    buffer_load_dwordx4 v218, s[48:51], s55 offen offset:2048 lds
    v_sub_f32 v72, v72, v5
    v_sub_f32 v73, v73, v5
    v_sub_f32 v74, v74, v5
    v_sub_f32 v75, v75, v5
    v_sub_f32 v76, v76, v5
    v_sub_f32 v77, v77, v5
    v_sub_f32 v78, v78, v5
    v_sub_f32_e64 v79, v79, v5
    s_waitcnt lgkmcnt(14)
    v_mfma_f32_32x32x16_bf16 v[56:71], v[36:39], v[20:23], v[56:71]
    ds_read_b128 v[32:35], v244 offset:12288
    ds_read_b128 v[36:39], v244 offset:13312
    ds_read_b64_tr_b16 a[24:25], v202 offset:18432
    ds_read_b64_tr_b16 a[26:27], v202 offset:19456
    buffer_load_dwordx4 v219, s[48:51], s55 offen offset:3072 lds
    ds_read_b64_tr_b16 a[28:29], v234 offset:18432
    ds_read_b64_tr_b16 a[30:31], v234 offset:19456
    v_sub_f32 v80, v80, v5
    v_sub_f32 v81, v81, v5
    v_sub_f32 v82, v82, v5
    v_sub_f32 v83, v83, v5
    v_sub_f32 v84, v84, v5
    v_sub_f32 v85, v85, v5
    v_sub_f32 v86, v86, v5
    v_sub_f32 v87, v87, v5
    s_waitcnt lgkmcnt(15)
    v_mfma_f32_32x32x16_bf16 v[88:103], v[24:27], v[16:19], v[104:119]
    v_exp_f32 v72, v72
    v_exp_f32 v73, v73
    v_exp_f32 v74, v74
    v_exp_f32 v75, v75
    v_cvt_pk_bf16_f32 v136, v72, v73
    v_mfma_f32_32x32x16_bf16 v[88:103], v[28:31], v[20:23], v[88:103]
    ds_read_b128 v[24:27], v244 offset:16384
    ds_read_b128 v[28:31], v244 offset:17408
    s_add_u32 m0, s23, 98304
    s_nop 0
    buffer_load_dwordx4 v216, s[32:35], s7 offen offset:0 lds
    v_exp_f32 v76, v76
    v_exp_f32 v77, v77
    v_cvt_pk_bf16_f32 v137, v74, v75
    v_exp_f32 v78, v78
    v_exp_f32 v79, v79
    v_cvt_pk_bf16_f32 v138, v76, v77
    v_exp_f32 v80, v80
    v_exp_f32 v81, v81
    v_cvt_pk_bf16_f32 v139, v78, v79
    v_exp_f32 v82, v82
    v_exp_f32 v83, v83
    v_cvt_pk_bf16_f32 v140, v80, v81
    v_exp_f32 v84, v84
    v_exp_f32 v85, v85
    v_cvt_pk_bf16_f32 v141, v82, v83
    v_exp_f32 v86, v86
    v_exp_f32 v87, v87
    v_cvt_pk_bf16_f32 v142, v84, v85
    v_cvt_pk_bf16_f32 v143, v86, v87
    v_and_b32 v144, v136, v236
    v_xor_b32 v152, v136, v144
    v_and_b32 v145, v137, v237
    v_xor_b32 v153, v137, v145
    v_and_b32 v146, v138, v238
    v_xor_b32 v154, v138, v146
    v_and_b32 v147, v139, v239
    v_xor_b32 v155, v139, v147
    v_and_b32 v148, v140, v240
    v_xor_b32 v156, v140, v148
    v_and_b32 v149, v141, v241
    v_xor_b32 v157, v141, v149
    v_and_b32 v150, v142, v242
    v_xor_b32 v158, v142, v150
    v_and_b32 v151, v143, v243
    v_xor_b32 v159, v143, v151
    v_mfma_f32_32x32x16_bf16 v[120:135], v[40:43], v[152:155], 0
    buffer_load_dwordx4 v217, s[32:35], s7 offen offset:1024 lds
    buffer_load_dwordx4 v218, s[32:35], s7 offen offset:2048 lds
    buffer_load_dwordx4 v219, s[32:35], s7 offen offset:3072 lds
    v_exp_f32 v56, v56
    v_exp_f32 v57, v57
    v_exp_f32 v58, v58
    v_exp_f32 v59, v59
    s_waitcnt lgkmcnt(15)
    v_mfma_f32_32x32x16_bf16 v[120:135], v[44:47], v[156:159], v[120:135]
    v_cvt_pk_bf16_f32 v136, v56, v57
    v_exp_f32 v60, v60
    v_exp_f32 v61, v61
    v_cvt_pk_bf16_f32 v137, v58, v59
    s_waitcnt lgkmcnt(14)
    v_mfma_f32_32x32x16_bf16 v[120:135], v[48:51], v[144:147], v[120:135]
    s_add_u32 m0, s23, 114688
    s_add_u32 s7, s7, 21504
    buffer_load_dwordx4 v216, s[32:35], s7 offen offset:0 lds
    v_exp_f32 v62, v62
    v_exp_f32 v63, v63
    v_cvt_pk_bf16_f32 v138, v60, v61
    v_exp_f32 v64, v64
    s_waitcnt lgkmcnt(12)
    v_mfma_f32_32x32x16_bf16 v[120:135], v[52:55], v[148:151], v[120:135]
    ds_read_b64_tr_b16 v[40:41], v245 offset:4096
    ds_read_b64_tr_b16 v[42:43], v246 offset:4096
    ds_read_b64_tr_b16 v[44:45], v245 offset:4352
    ds_read_b64_tr_b16 v[46:47], v246 offset:4352
    ds_read_b64_tr_b16 v[48:49], v245 offset:8192
    ds_read_b64_tr_b16 v[50:51], v246 offset:8192
    ds_read_b64_tr_b16 v[52:53], v245 offset:8448
    ds_read_b64_tr_b16 v[54:55], v246 offset:8448
    buffer_load_dwordx4 v217, s[32:35], s7 offen offset:1024 lds
    v_exp_f32 v65, v65
    v_cvt_pk_bf16_f32 v139, v62, v63
    v_exp_f32 v66, v66
    v_exp_f32 v67, v67
    s_waitcnt lgkmcnt(15)
    v_mfma_f32_32x32x16_bf16 v[72:87], v[32:35], v[16:19], v[104:119]
    buffer_load_dwordx4 v218, s[32:35], s7 offen offset:2048 lds
    v_cvt_pk_bf16_f32 v140, v64, v65
    v_exp_f32 v68, v68
    v_exp_f32 v69, v69
    v_cvt_pk_bf16_f32 v141, v66, v67
    s_waitcnt lgkmcnt(14)
    v_mfma_f32_32x32x16_bf16 v[72:87], v[36:39], v[20:23], v[72:87]
    ds_read_b128 v[32:35], v244 offset:20480
    ds_read_b128 v[36:39], v244 offset:21504
    v_exp_f32 v70, v70
    v_exp_f32 v71, v71
    v_cvt_pk_bf16_f32 v142, v68, v69
    v_cvt_pk_bf16_f32 v143, v70, v71
    s_waitcnt lgkmcnt(8)
    v_mfma_f32_32x32x16_bf16 v[120:135], v[40:43], v[136:139], v[120:135]
    buffer_load_dwordx4 v219, s[32:35], s7 offen offset:3072 lds
    v_exp_f32 v88, v88
    v_exp_f32 v89, v89
    v_exp_f32 v90, v90
    v_exp_f32 v91, v91
    v_cvt_pk_bf16_f32 v152, v88, v89
    v_exp_f32 v92, v92
    s_waitcnt lgkmcnt(6)
    v_mfma_f32_32x32x16_bf16 v[120:135], v[44:47], v[140:143], v[120:135]
    ds_read_b64_tr_b16 v[40:41], v245 offset:12288
    ds_read_b64_tr_b16 v[42:43], v246 offset:12288
    ds_read_b64_tr_b16 v[44:45], v245 offset:12544
    ds_read_b64_tr_b16 v[46:47], v246 offset:12544
    s_add_u32 m0, s23, 131072
    s_add_u32 s7, s7, 28672
    buffer_load_dwordx4 v216, s[32:35], s7 offen offset:0 lds
    v_exp_f32 v93, v93
    v_cvt_pk_bf16_f32 v153, v90, v91
    v_exp_f32 v94, v94
    v_exp_f32 v95, v95
    v_cvt_pk_bf16_f32 v154, v92, v93
    v_exp_f32 v96, v96
    v_mfma_f32_32x32x16_bf16 v[56:71], v[24:27], v[16:19], v[104:119]
    buffer_load_dwordx4 v217, s[32:35], s7 offen offset:1024 lds
    v_exp_f32 v97, v97
    v_cvt_pk_bf16_f32 v155, v94, v95
    v_exp_f32 v98, v98
    v_exp_f32 v99, v99
    v_cvt_pk_bf16_f32 v156, v96, v97
    v_exp_f32 v100, v100
    v_mfma_f32_32x32x16_bf16 v[56:71], v[28:31], v[20:23], v[56:71]
    ds_read_b128 v[24:27], v244 offset:24576
    ds_read_b128 v[28:31], v244 offset:25600
    buffer_load_dwordx4 v218, s[32:35], s7 offen offset:2048 lds
    v_exp_f32 v101, v101
    v_cvt_pk_bf16_f32 v157, v98, v99
    v_exp_f32 v102, v102
    v_exp_f32 v103, v103
    v_cvt_pk_bf16_f32 v158, v100, v101
    v_cvt_pk_bf16_f32 v159, v102, v103
    s_waitcnt lgkmcnt(10)
    v_mfma_f32_32x32x16_bf16 v[120:135], v[48:51], v[152:155], v[120:135]
    buffer_load_dwordx2 v[8:9], v231, s[40:43], 0 offen sc1
    v_exp_f32 v72, v72
    v_exp_f32 v73, v73
    v_exp_f32 v74, v74
    v_exp_f32 v75, v75
    v_cvt_pk_bf16_f32 v136, v72, v73
    v_exp_f32 v76, v76
    s_waitcnt lgkmcnt(8)
    v_mfma_f32_32x32x16_bf16 v[120:135], v[52:55], v[156:159], v[120:135]
    ds_read_b64_tr_b16 v[48:49], v245 offset:16384
    ds_read_b64_tr_b16 v[50:51], v246 offset:16384
    ds_read_b64_tr_b16 v[52:53], v245 offset:16640
    ds_read_b64_tr_b16 v[54:55], v246 offset:16640
    buffer_load_dwordx4 v219, s[32:35], s7 offen offset:3072 lds
    s_add_u32 m0, s23, 147456
    s_add_u32 s7, s7, 21504
    buffer_load_dwordx4 v216, s[32:35], s7 offen offset:0 lds
    v_exp_f32 v77, v77
    v_cvt_pk_bf16_f32 v137, v74, v75
    v_exp_f32 v78, v78
    v_exp_f32 v79, v79
    v_cvt_pk_bf16_f32 v138, v76, v77
    v_exp_f32 v80, v80
    s_waitcnt lgkmcnt(11)
    v_mfma_f32_32x32x16_bf16 v[88:103], v[32:35], v[16:19], v[104:119]
    v_exp_f32 v81, v81
    v_cvt_pk_bf16_f32 v139, v78, v79
    v_exp_f32 v82, v82
    v_exp_f32 v83, v83
    v_cvt_pk_bf16_f32 v140, v80, v81
    v_exp_f32 v84, v84
    s_waitcnt lgkmcnt(10)
    v_mfma_f32_32x32x16_bf16 v[88:103], v[36:39], v[20:23], v[88:103]
    ds_read_b128 v[32:35], v244 offset:28672
    ds_read_b128 v[36:39], v244 offset:29696
    buffer_load_dwordx4 v217, s[32:35], s7 offen offset:1024 lds
    v_exp_f32 v85, v85
    v_cvt_pk_bf16_f32 v141, v82, v83
    v_exp_f32 v86, v86
    v_exp_f32 v87, v87
    v_cvt_pk_bf16_f32 v142, v84, v85
    v_cvt_pk_bf16_f32 v143, v86, v87
    s_waitcnt lgkmcnt(10)
    v_mfma_f32_32x32x16_bf16 v[120:135], v[40:43], v[136:139], v[120:135]
    buffer_load_dwordx4 v218, s[32:35], s7 offen offset:2048 lds
    v_exp_f32 v56, v56
    v_exp_f32 v57, v57
    v_exp_f32 v58, v58
    v_exp_f32 v59, v59
    v_cvt_pk_bf16_f32 v144, v56, v57
    v_exp_f32 v60, v60
    s_waitcnt lgkmcnt(8)
    v_mfma_f32_32x32x16_bf16 v[120:135], v[44:47], v[140:143], v[120:135]
    ds_read_b64_tr_b16 v[40:41], v245 offset:20480
    ds_read_b64_tr_b16 v[42:43], v246 offset:20480
    ds_read_b64_tr_b16 v[44:45], v245 offset:20736
    ds_read_b64_tr_b16 v[46:47], v246 offset:20736
    buffer_load_dwordx4 v219, s[32:35], s7 offen offset:3072 lds
    v_exp_f32 v61, v61
    v_cvt_pk_bf16_f32 v145, v58, v59
    v_exp_f32 v62, v62
    v_exp_f32 v63, v63
    v_cvt_pk_bf16_f32 v146, v60, v61
    v_exp_f32 v64, v64
    s_waitcnt lgkmcnt(11)
    v_mfma_f32_32x32x16_bf16 v[72:87], v[24:27], v[16:19], v[104:119]
    v_exp_f32 v65, v65
    v_cvt_pk_bf16_f32 v147, v62, v63
    v_exp_f32 v66, v66
    v_exp_f32 v67, v67
    v_cvt_pk_bf16_f32 v148, v64, v65
    v_exp_f32 v68, v68
    s_waitcnt lgkmcnt(10)
    v_mfma_f32_32x32x16_bf16 v[72:87], v[28:31], v[20:23], v[72:87]
    v_exp_f32 v69, v69
    v_cvt_pk_bf16_f32 v149, v66, v67
    v_exp_f32 v70, v70
    v_exp_f32 v71, v71
    v_cvt_pk_bf16_f32 v150, v68, v69
    v_cvt_pk_bf16_f32 v151, v70, v71
    s_waitcnt lgkmcnt(8)
    v_mfma_f32_32x32x16_bf16 v[120:135], v[48:51], v[144:147], v[120:135]
    v_exp_f32 v88, v88
    v_exp_f32 v89, v89
    v_exp_f32 v90, v90
    v_exp_f32 v91, v91
    v_cvt_pk_bf16_f32 v136, v88, v89
    v_exp_f32 v92, v92
    s_waitcnt lgkmcnt(6)
    v_mfma_f32_32x32x16_bf16 v[120:135], v[52:55], v[148:151], v[120:135]
    ds_read_b64_tr_b16 v[48:49], v245 offset:24576
    ds_read_b64_tr_b16 v[50:51], v246 offset:24576
    ds_read_b64_tr_b16 v[52:53], v245 offset:24832
    ds_read_b64_tr_b16 v[54:55], v246 offset:24832
    v_exp_f32 v93, v93
    v_cvt_pk_bf16_f32 v137, v90, v91
    v_exp_f32 v94, v94
    v_exp_f32 v95, v95
    v_cvt_pk_bf16_f32 v138, v92, v93
    v_exp_f32 v96, v96
    s_waitcnt lgkmcnt(9)
    v_mfma_f32_32x32x16_bf16 v[56:71], v[32:35], v[16:19], v[104:119]
    v_exp_f32 v97, v97
    v_cvt_pk_bf16_f32 v139, v94, v95
    v_exp_f32 v98, v98
    v_exp_f32 v99, v99
    v_cvt_pk_bf16_f32 v140, v96, v97
    v_exp_f32 v100, v100
    s_waitcnt lgkmcnt(8)
    v_mfma_f32_32x32x16_bf16 v[56:71], v[36:39], v[20:23], v[56:71]
    v_exp_f32 v101, v101
    v_cvt_pk_bf16_f32 v141, v98, v99
    v_exp_f32 v102, v102
    v_exp_f32 v103, v103
    v_cvt_pk_bf16_f32 v142, v100, v101
    v_cvt_pk_bf16_f32 v143, v102, v103
    s_waitcnt lgkmcnt(6)
    v_mfma_f32_32x32x16_bf16 v[120:135], v[40:43], v[136:139], v[120:135]
    s_waitcnt vmcnt(5)
    v_cmp_ne_u64 vcc, s[26:27], v[8:9]
    s_cbranch_vccnz L_pc2_slow
L_pc2_back:
    buffer_load_dwordx4 a[32:35], v220, s[40:43], s4 offen offset:0 sc1
    buffer_load_dwordx4 a[36:39], v221, s[40:43], s4 offen offset:0 sc1
    buffer_load_dwordx4 a[40:43], v220, s[40:43], s4 offen offset:1024 sc1
    v_exp_f32 v72, v72
    v_exp_f32 v73, v73
    v_exp_f32 v74, v74
    v_exp_f32 v75, v75
    v_cvt_pk_bf16_f32 v144, v72, v73
    v_exp_f32 v76, v76
    v_exp_f32 v77, v77
    v_cvt_pk_bf16_f32 v145, v74, v75
    v_exp_f32 v78, v78
    v_exp_f32 v79, v79
    v_cvt_pk_bf16_f32 v146, v76, v77
    v_exp_f32 v80, v80
    s_waitcnt lgkmcnt(4)
    v_mfma_f32_32x32x16_bf16 v[120:135], v[44:47], v[140:143], v[120:135]
    ds_read_b64_tr_b16 v[40:41], v245 offset:28672
    ds_read_b64_tr_b16 v[42:43], v246 offset:28672
    ds_read_b64_tr_b16 v[44:45], v245 offset:28928
    ds_read_b64_tr_b16 v[46:47], v246 offset:28928
    buffer_load_dwordx4 a[44:47], v221, s[40:43], s4 offen offset:1024 sc1
    v_exp_f32 v81, v81
    v_cvt_pk_bf16_f32 v147, v78, v79
    v_exp_f32 v82, v82
    v_exp_f32 v83, v83
    v_cvt_pk_bf16_f32 v148, v80, v81
    v_exp_f32 v84, v84
    v_exp_f32 v85, v85
    v_cvt_pk_bf16_f32 v149, v82, v83
    v_exp_f32 v86, v86
    v_exp_f32 v87, v87
    v_cvt_pk_bf16_f32 v150, v84, v85
    v_cvt_pk_bf16_f32 v151, v86, v87
    s_waitcnt lgkmcnt(6)
    v_mfma_f32_32x32x16_bf16 v[120:135], v[48:51], v[144:147], v[120:135]
    buffer_load_dwordx4 a[48:51], v220, s[40:43], s4 offen offset:2048 sc1
    buffer_load_dwordx4 a[52:55], v221, s[40:43], s4 offen offset:2048 sc1
    v_exp_f32 v56, v56
    v_exp_f32 v57, v57
    v_exp_f32 v58, v58
    v_exp_f32 v59, v59
    v_cvt_pk_bf16_f32 v136, v56, v57
    v_exp_f32 v60, v60
    v_exp_f32 v61, v61
    v_cvt_pk_bf16_f32 v137, v58, v59
    v_exp_f32 v62, v62
    v_exp_f32 v63, v63
    v_cvt_pk_bf16_f32 v138, v60, v61
    v_exp_f32 v64, v64
    s_waitcnt lgkmcnt(4)
    v_mfma_f32_32x32x16_bf16 v[120:135], v[52:55], v[148:151], v[120:135]
    buffer_load_dwordx4 a[56:59], v220, s[40:43], s4 offen offset:3072 sc1
    v_exp_f32 v65, v65
    v_cvt_pk_bf16_f32 v139, v62, v63
    v_exp_f32 v66, v66
    v_exp_f32 v67, v67
    v_cvt_pk_bf16_f32 v140, v64, v65
    v_exp_f32 v68, v68
    v_exp_f32 v69, v69
    v_cvt_pk_bf16_f32 v141, v66, v67
    v_exp_f32 v70, v70
    v_exp_f32 v71, v71
    v_cvt_pk_bf16_f32 v142, v68, v69
    v_cvt_pk_bf16_f32 v143, v70, v71
    s_waitcnt lgkmcnt(2)
    v_mfma_f32_32x32x16_bf16 v[120:135], v[40:43], v[136:139], v[120:135]
    buffer_load_dwordx4 a[60:63], v221, s[40:43], s4 offen offset:3072 sc1
    s_waitcnt lgkmcnt(0)
    v_mfma_f32_32x32x16_bf16 v[120:135], v[44:47], v[140:143], v[120:135]
    s_waitcnt vmcnt(7)
    v_mfma_f32_32x32x16_bf16 v[16:31], a[112:115], a[32:35], 0
    s_add_u32 s4, s4, 4096
    buffer_load_dwordx4 v[80:83], v220, s[40:43], s4 offen offset:0 sc1
    s_cmp_eq_u32 s101, 0
    s_cselect_b64 s[56:57], -1, 0
    s_cselect_b32 s64, 0, -1
    s_cselect_b32 s67, -1, 0
    s_mov_b32 s65, 0
    s_mov_b32 s66, 0
    s_nop 1
    v_cndmask_b32_e64 v11, v120, v132, s[56:57]
    v_mfma_f32_32x32x16_bf16 v[32:47], a[116:119], a[32:35], 0
    buffer_load_dwordx4 v[84:87], v221, s[40:43], s4 offen offset:0 sc1
    v_mov_b32 v12, v11
    s_nop 1
    v_permlane32_swap_b32 v11, v12
    v_cndmask_b32_e64 v11, v11, v12, s[56:57]
    v_rcp_f32 v11, v11
    s_nop 0
    v_mul_f32 v12, v11, v254
    v_mul_f32 v120, v12, v120
    v_mul_f32 v121, v12, v121
    s_waitcnt vmcnt(8)
    v_mfma_f32_32x32x16_bf16 v[48:63], a[112:115], a[36:39], 0
    buffer_load_dwordx4 v[88:91], v220, s[40:43], s4 offen offset:1024 sc1
    v_mul_f32 v122, v12, v122
    v_mul_f32 v123, v12, v123
    v_mul_f32 v124, v12, v124
    v_mul_f32 v125, v12, v125
    v_mul_f32 v126, v12, v126
    v_mul_f32_e64 v127, v12, v127
    v_cvt_pk_bf16_f32 v136, v120, v121
    v_mfma_f32_32x32x16_bf16 v[64:79], a[116:119], a[36:39], 0
    buffer_load_dwordx4 v[92:95], v221, s[40:43], s4 offen offset:1024 sc1
    v_cvt_pk_bf16_f32 v137, v122, v123
    v_cvt_pk_bf16_f32 v138, v124, v125
    v_cvt_pk_bf16_f32 v139, v126, v127
    v_cndmask_b32_e64 v136, v136, 0, s[64:65]
    v_cndmask_b32_e64 v137, v137, 0, s[64:65]
    buffer_store_dwordx4 v[136:139], v2, s[40:43], s18 offen offset:0 sc1
    v_mul_f32 v128, v12, v128
    s_waitcnt vmcnt(10)
    v_mfma_f32_32x32x16_bf16 v[16:31], a[120:123], a[40:43], v[16:31]
    buffer_load_dwordx4 v[96:99], v220, s[40:43], s4 offen offset:2048 sc1
    v_mul_f32 v129, v12, v129
    v_mul_f32 v130, v12, v130
    v_mul_f32 v131, v12, v131
    v_mul_f32 v132, v12, v132
    v_mul_f32 v133, v12, v133
    v_mul_f32 v134, v12, v134
    v_mul_f32_e64 v135, v12, v135
    v_mfma_f32_32x32x16_bf16 v[32:47], a[124:127], a[40:43], v[32:47]
    buffer_load_dwordx4 v[100:103], v221, s[40:43], s4 offen offset:2048 sc1
    v_cvt_pk_bf16_f32 v140, v128, v129
    v_cvt_pk_bf16_f32 v141, v130, v131
    v_cvt_pk_bf16_f32 v142, v132, v133
    v_cvt_pk_bf16_f32 v143, v134, v135
    v_cndmask_b32_e64 v142, v142, 0, s[66:67]
    v_cndmask_b32_e64 v143, v143, 0, s[66:67]
    buffer_store_dwordx4 v[140:143], v2, s[40:43], s18 offen offset:1024 sc1
    s_waitcnt vmcnt(12)
    v_mfma_f32_32x32x16_bf16 v[48:63], a[120:123], a[44:47], v[48:63]
    buffer_load_dwordx4 v[104:107], v220, s[40:43], s4 offen offset:3072 sc1
    v_mfma_f32_32x32x16_bf16 v[64:79], a[124:127], a[44:47], v[64:79]
    buffer_load_dwordx4 v[108:111], v221, s[40:43], s4 offen offset:3072 sc1
    s_waitcnt vmcnt(13)
    v_mfma_f32_32x32x16_bf16 v[16:31], a[128:131], a[48:51], v[16:31]
    s_add_u32 s4, s4, 4096
    buffer_load_dwordx4 v[112:115], v220, s[40:43], s4 offen offset:0 sc1
    v_mfma_f32_32x32x16_bf16 v[32:47], a[132:135], a[48:51], v[32:47]
    s_waitcnt vmcnt(13)
    v_mfma_f32_32x32x16_bf16 v[48:63], a[128:131], a[52:55], v[48:63]
    buffer_load_dwordx4 v[116:119], v221, s[40:43], s4 offen offset:0 sc1
    v_mfma_f32_32x32x16_bf16 v[64:79], a[132:135], a[52:55], v[64:79]
    s_waitcnt lgkmcnt(0)
    s_barrier
    s_waitcnt vmcnt(13)
    v_mfma_f32_32x32x16_bf16 v[16:31], a[136:139], a[56:59], v[16:31]
    buffer_load_dwordx4 v[144:147], v220, s[40:43], s4 offen offset:1024 sc1
    v_mfma_f32_32x32x16_bf16 v[32:47], a[140:143], a[56:59], v[32:47]
    s_waitcnt vmcnt(13)
    v_mfma_f32_32x32x16_bf16 v[48:63], a[136:139], a[60:63], v[48:63]
    buffer_load_dwordx4 v[148:151], v221, s[40:43], s4 offen offset:1024 sc1
    v_mfma_f32_32x32x16_bf16 v[64:79], a[140:143], a[60:63], v[64:79]
    s_waitcnt vmcnt(13)
    v_mfma_f32_32x32x16_bf16 v[16:31], a[144:147], v[80:83], v[16:31]
    buffer_load_dwordx4 v[152:155], v220, s[40:43], s4 offen offset:2048 sc1
    v_mfma_f32_32x32x16_bf16 v[32:47], a[148:151], v[80:83], v[32:47]
    s_waitcnt vmcnt(13)
    v_mfma_f32_32x32x16_bf16 v[48:63], a[144:147], v[84:87], v[48:63]
    buffer_load_dwordx4 v[156:159], v221, s[40:43], s4 offen offset:2048 sc1
    v_mfma_f32_32x32x16_bf16 v[64:79], a[148:151], v[84:87], v[64:79]
    s_waitcnt vmcnt(13)
    v_mfma_f32_32x32x16_bf16 v[16:31], a[152:155], v[88:91], v[16:31]
    buffer_load_dwordx4 v[236:239], v220, s[40:43], s4 offen offset:3072 sc1
    v_mfma_f32_32x32x16_bf16 v[32:47], a[156:159], v[88:91], v[32:47]
    buffer_load_dwordx4 v[240:243], v221, s[40:43], s4 offen offset:3072 sc1
    s_waitcnt vmcnt(14)
    v_mfma_f32_32x32x16_bf16 v[48:63], a[152:155], v[92:95], v[48:63]
    s_waitcnt vmcnt(10)
    buffer_store_dwordx2 v[6:7], v4, s[40:43], s25 offen sc1
    v_mfma_f32_32x32x16_bf16 v[64:79], a[156:159], v[92:95], v[64:79]
    v_mfma_f32_32x32x16_bf16 v[16:31], a[160:163], v[96:99], v[16:31]
    s_add_u32 s4, s4, 4096
    buffer_load_dwordx4 v[244:247], v220, s[40:43], s4 offen offset:0 sc1
    v_mfma_f32_32x32x16_bf16 v[32:47], a[164:167], v[96:99], v[32:47]
    v_mfma_f32_32x32x16_bf16 v[48:63], a[160:163], v[100:103], v[48:63]
    buffer_load_dwordx4 v[248:251], v221, s[40:43], s4 offen offset:0 sc1
    v_mfma_f32_32x32x16_bf16 v[64:79], a[164:167], v[100:103], v[64:79]
    s_waitcnt vmcnt(12)
    v_mfma_f32_32x32x16_bf16 v[16:31], a[168:171], v[104:107], v[16:31]
    buffer_load_dwordx4 v[120:123], v220, s[40:43], s4 offen offset:1024 sc1
    v_mfma_f32_32x32x16_bf16 v[32:47], a[172:175], v[104:107], v[32:47]
    s_waitcnt vmcnt(12)
    v_mfma_f32_32x32x16_bf16 v[48:63], a[168:171], v[108:111], v[48:63]
    buffer_load_dwordx4 v[124:127], v221, s[40:43], s4 offen offset:1024 sc1
    v_mfma_f32_32x32x16_bf16 v[64:79], a[172:175], v[108:111], v[64:79]
    s_waitcnt vmcnt(12)
    v_mfma_f32_32x32x16_bf16 v[16:31], a[176:179], v[112:115], v[16:31]
    buffer_load_dwordx4 v[128:131], v220, s[40:43], s4 offen offset:2048 sc1
    v_mfma_f32_32x32x16_bf16 v[32:47], a[180:183], v[112:115], v[32:47]
    ds_read_b64_tr_b16 a[112:113], v232 offset:49152
    ds_read_b64_tr_b16 a[114:115], v232 offset:50176
    s_waitcnt vmcnt(12)
    v_mfma_f32_32x32x16_bf16 v[48:63], a[176:179], v[116:119], v[48:63]
    buffer_load_dwordx4 v[132:135], v221, s[40:43], s4 offen offset:2048 sc1
    v_mfma_f32_32x32x16_bf16 v[64:79], a[180:183], v[116:119], v[64:79]
    ds_read_b64_tr_b16 a[116:117], v233 offset:49152
    ds_read_b64_tr_b16 a[118:119], v233 offset:50176
    s_waitcnt vmcnt(12)
    v_mfma_f32_32x32x16_bf16 v[16:31], a[184:187], v[144:147], v[16:31]
    buffer_load_dwordx4 v[136:139], v220, s[40:43], s4 offen offset:3072 sc1
    v_mfma_f32_32x32x16_bf16 v[32:47], a[188:191], v[144:147], v[32:47]
    ds_read_b64_tr_b16 a[120:121], v232 offset:51200
    ds_read_b64_tr_b16 a[122:123], v232 offset:52224
    s_waitcnt vmcnt(12)
    v_mfma_f32_32x32x16_bf16 v[48:63], a[184:187], v[148:151], v[48:63]
    buffer_load_dwordx4 v[140:143], v221, s[40:43], s4 offen offset:3072 sc1
    v_mfma_f32_32x32x16_bf16 v[64:79], a[188:191], v[148:151], v[64:79]
    ds_read_b64_tr_b16 a[124:125], v233 offset:51200
    ds_read_b64_tr_b16 a[126:127], v233 offset:52224
    s_waitcnt vmcnt(12)
    v_mfma_f32_32x32x16_bf16 v[16:31], a[192:195], v[152:155], v[16:31]
    s_add_u32 s4, s4, 4096
    buffer_load_dwordx4 a[64:67], v220, s[40:43], s4 offen offset:0 sc1
    v_mfma_f32_32x32x16_bf16 v[32:47], a[196:199], v[152:155], v[32:47]
    ds_read_b64_tr_b16 a[128:129], v0 offset:0
    ds_read_b64_tr_b16 a[130:131], v0 offset:1024
    s_waitcnt vmcnt(12)
    v_mfma_f32_32x32x16_bf16 v[48:63], a[192:195], v[156:159], v[48:63]
    buffer_load_dwordx4 a[68:71], v221, s[40:43], s4 offen offset:0 sc1
    v_mfma_f32_32x32x16_bf16 v[64:79], a[196:199], v[156:159], v[64:79]
    ds_read_b64_tr_b16 a[132:133], v230 offset:0
    ds_read_b64_tr_b16 a[134:135], v230 offset:1024
    s_waitcnt vmcnt(12)
    v_mfma_f32_32x32x16_bf16 v[16:31], a[200:203], v[236:239], v[16:31]
    buffer_load_dwordx4 a[72:75], v220, s[40:43], s4 offen offset:1024 sc1
    v_mfma_f32_32x32x16_bf16 v[32:47], a[204:207], v[236:239], v[32:47]
    ds_read_b64_tr_b16 a[136:137], v0 offset:2048
    ds_read_b64_tr_b16 a[138:139], v0 offset:3072
    ds_read_b64_tr_b16 a[140:141], v230 offset:2048
    ds_read_b64_tr_b16 a[142:143], v230 offset:3072
    s_add_u32 s56, s23, 49152
    s_waitcnt vmcnt(12)
    v_mfma_f32_32x32x16_bf16 v[48:63], a[200:203], v[240:243], v[48:63]
    buffer_load_dwordx4 a[76:79], v221, s[40:43], s4 offen offset:1024 sc1
    v_mfma_f32_32x32x16_bf16 v[64:79], a[204:207], v[240:243], v[64:79]
    v_lshlrev_b32 v12, 16, v235
    v_and_b32 v13, 0xffff0000, v235
    v_lshl_add_u32 v14, v1, 3, s56
    s_waitcnt vmcnt(11)
    v_mfma_f32_32x32x16_bf16 v[16:31], a[208:211], v[244:247], v[16:31]
    buffer_load_dwordx4 a[80:83], v220, s[40:43], s4 offen offset:2048 sc1
    v_mfma_f32_32x32x16_bf16 v[32:47], a[212:215], v[244:247], v[32:47]
    ds_read_b64_tr_b16 a[144:145], v0 offset:16384
    ds_read_b64_tr_b16 a[146:147], v0 offset:17408
    ds_read_b64_tr_b16 a[148:149], v230 offset:16384
    ds_read_b64_tr_b16 a[150:151], v230 offset:17408
    ds_write_b64 v14, v[12:13]
    s_waitcnt vmcnt(11)
    v_mfma_f32_32x32x16_bf16 v[48:63], a[208:211], v[248:251], v[48:63]
    buffer_load_dwordx4 a[84:87], v221, s[40:43], s4 offen offset:2048 sc1
    v_mfma_f32_32x32x16_bf16 v[64:79], a[212:215], v[248:251], v[64:79]
    v_lshrrev_b32 v10, 5, v1
    v_lshl_add_u32 v10, v10, 5, s56
    s_lshr_b32 s58, s3, 1
    s_waitcnt vmcnt(11)
    v_mfma_f32_32x32x16_bf16 v[16:31], a[216:219], v[120:123], v[16:31]
    buffer_load_dwordx4 a[88:91], v220, s[40:43], s4 offen offset:3072 sc1
    v_mfma_f32_32x32x16_bf16 v[32:47], a[220:223], v[120:123], v[32:47]
    ds_read_b64_tr_b16 a[152:153], v0 offset:18432
    ds_read_b64_tr_b16 a[154:155], v0 offset:19456
    ds_read_b64_tr_b16 a[156:157], v230 offset:18432
    ds_read_b64_tr_b16 a[158:159], v230 offset:19456
    s_lshl_b32 s58, s58, 7
    s_waitcnt vmcnt(11)
    v_mfma_f32_32x32x16_bf16 v[48:63], a[216:219], v[124:127], v[48:63]
    buffer_load_dwordx4 a[92:95], v221, s[40:43], s4 offen offset:3072 sc1
    v_mfma_f32_32x32x16_bf16 v[64:79], a[220:223], v[124:127], v[64:79]
    v_add_u32 v10, s58, v10
    v_sub_f32 v222, 1.0, v222
    v_sub_f32 v223, 1.0, v223
    s_waitcnt vmcnt(11)
    v_mfma_f32_32x32x16_bf16 v[16:31], a[224:227], v[128:131], v[16:31]
    s_add_u32 s4, s4, 4096
    buffer_load_dwordx4 a[96:99], v220, s[40:43], s4 offen offset:0 sc1
    v_mfma_f32_32x32x16_bf16 v[32:47], a[228:231], v[128:131], v[32:47]
    ds_read_b64_tr_b16 a[160:161], v0 offset:32768
    ds_read_b64_tr_b16 a[162:163], v0 offset:33792
    s_waitcnt vmcnt(11)
    v_mfma_f32_32x32x16_bf16 v[48:63], a[224:227], v[132:135], v[48:63]
    buffer_load_dwordx4 a[100:103], v221, s[40:43], s4 offen offset:0 sc1
    v_mfma_f32_32x32x16_bf16 v[64:79], a[228:231], v[132:135], v[64:79]
    ds_read_b64_tr_b16 a[164:165], v230 offset:32768
    ds_read_b64_tr_b16 a[166:167], v230 offset:33792
    s_waitcnt vmcnt(11)
    v_mfma_f32_32x32x16_bf16 v[16:31], a[232:235], v[136:139], v[16:31]
    buffer_load_dwordx4 a[104:107], v220, s[40:43], s4 offen offset:1024 sc1
    v_mfma_f32_32x32x16_bf16 v[32:47], a[236:239], v[136:139], v[32:47]
    buffer_load_dwordx4 a[108:111], v221, s[40:43], s4 offen offset:1024 sc1
    ds_read_b64_tr_b16 a[168:169], v0 offset:34816
    ds_read_b64_tr_b16 a[170:171], v0 offset:35840
    s_waitcnt vmcnt(12)
    v_mfma_f32_32x32x16_bf16 v[48:63], a[232:235], v[140:143], v[48:63]
    buffer_load_dwordx2 v[8:9], v229, s[40:43], 0 offen sc1
    v_mfma_f32_32x32x16_bf16 v[64:79], a[236:239], v[140:143], v[64:79]
    ds_read_b64_tr_b16 a[172:173], v230 offset:34816
    ds_read_b64_tr_b16 a[174:175], v230 offset:35840
    s_waitcnt vmcnt(12)
    v_mfma_f32_32x32x16_bf16 v[16:31], a[240:243], a[64:67], v[16:31]
    buffer_load_dwordx4 v[160:163], v220, s[40:43], s4 offen offset:2048 sc1
    v_mfma_f32_32x32x16_bf16 v[32:47], a[244:247], a[64:67], v[32:47]
    ds_read_b64_tr_b16 a[176:177], v0 offset:49152
    ds_read_b64_tr_b16 a[178:179], v0 offset:50176
    s_waitcnt vmcnt(12)
    v_mfma_f32_32x32x16_bf16 v[48:63], a[240:243], a[68:71], v[48:63]
    buffer_load_dwordx4 v[164:167], v221, s[40:43], s4 offen offset:2048 sc1
    v_mfma_f32_32x32x16_bf16 v[64:79], a[244:247], a[68:71], v[64:79]
    ds_read_b64_tr_b16 a[180:181], v230 offset:49152
    ds_read_b64_tr_b16 a[182:183], v230 offset:50176
    s_waitcnt vmcnt(12)
    v_mfma_f32_32x32x16_bf16 v[16:31], a[248:251], a[72:75], v[16:31]
    buffer_load_dwordx4 v[168:171], v220, s[40:43], s4 offen offset:3072 sc1
    v_mfma_f32_32x32x16_bf16 v[32:47], a[252:255], a[72:75], v[32:47]
    ds_read_b64_tr_b16 a[184:185], v0 offset:51200
    ds_read_b64_tr_b16 a[186:187], v0 offset:52224
    s_waitcnt vmcnt(12)
    v_mfma_f32_32x32x16_bf16 v[48:63], a[248:251], a[76:79], v[48:63]
    buffer_load_dwordx4 v[172:175], v221, s[40:43], s4 offen offset:3072 sc1
    v_mfma_f32_32x32x16_bf16 v[64:79], a[252:255], a[76:79], v[64:79]
    ds_read_b64_tr_b16 a[188:189], v230 offset:51200
    ds_read_b64_tr_b16 a[190:191], v230 offset:52224
    s_waitcnt vmcnt(12)
    v_mfma_f32_32x32x16_bf16 v[16:31], a[0:3], a[80:83], v[16:31]
    s_add_u32 s4, s4, 4096
    buffer_load_dwordx4 v[176:179], v220, s[40:43], s4 offen offset:0 sc1
    v_mfma_f32_32x32x16_bf16 v[32:47], a[4:7], a[80:83], v[32:47]
    ds_read_b64_tr_b16 a[192:193], v202 offset:0
    ds_read_b64_tr_b16 a[194:195], v202 offset:1024
    s_waitcnt vmcnt(12)
    v_mfma_f32_32x32x16_bf16 v[48:63], a[0:3], a[84:87], v[48:63]
    buffer_load_dwordx4 v[180:183], v221, s[40:43], s4 offen offset:0 sc1
    v_mfma_f32_32x32x16_bf16 v[64:79], a[4:7], a[84:87], v[64:79]
    ds_read_b64_tr_b16 a[196:197], v234 offset:0
    ds_read_b64_tr_b16 a[198:199], v234 offset:1024
    s_waitcnt vmcnt(12)
    v_mfma_f32_32x32x16_bf16 v[16:31], a[8:11], a[88:91], v[16:31]
    buffer_load_dwordx4 v[184:187], v220, s[40:43], s4 offen offset:1024 sc1
    v_mfma_f32_32x32x16_bf16 v[32:47], a[12:15], a[88:91], v[32:47]
    ds_read_b64_tr_b16 a[200:201], v202 offset:2048
    ds_read_b64_tr_b16 a[202:203], v202 offset:3072
    s_waitcnt vmcnt(12)
    v_mfma_f32_32x32x16_bf16 v[48:63], a[8:11], a[92:95], v[48:63]
    buffer_load_dwordx4 v[188:191], v221, s[40:43], s4 offen offset:1024 sc1
    v_mfma_f32_32x32x16_bf16 v[64:79], a[12:15], a[92:95], v[64:79]
    ds_read_b64_tr_b16 a[204:205], v234 offset:2048
    ds_read_b64_tr_b16 a[206:207], v234 offset:3072
    s_waitcnt vmcnt(12)
    v_mfma_f32_32x32x16_bf16 v[16:31], a[16:19], a[96:99], v[16:31]
    buffer_load_dwordx4 v[192:195], v220, s[40:43], s4 offen offset:2048 sc1
    v_mfma_f32_32x32x16_bf16 v[32:47], a[20:23], a[96:99], v[32:47]
    ds_read_b64_tr_b16 a[208:209], v202 offset:16384
    ds_read_b64_tr_b16 a[210:211], v202 offset:17408
    s_waitcnt vmcnt(12)
    v_mfma_f32_32x32x16_bf16 v[48:63], a[16:19], a[100:103], v[48:63]
    buffer_load_dwordx4 v[196:199], v221, s[40:43], s4 offen offset:2048 sc1
    v_mfma_f32_32x32x16_bf16 v[64:79], a[20:23], a[100:103], v[64:79]
    ds_read_b64_tr_b16 a[212:213], v234 offset:16384
    ds_read_b64_tr_b16 a[214:215], v234 offset:17408
    s_waitcnt vmcnt(12)
    v_mfma_f32_32x32x16_bf16 v[16:31], a[24:27], a[104:107], v[16:31]
    buffer_load_dwordx4 v[204:207], v220, s[40:43], s4 offen offset:3072 sc1
    v_mfma_f32_32x32x16_bf16 v[32:47], a[28:31], a[104:107], v[32:47]
    ds_read_b64_tr_b16 a[216:217], v202 offset:18432
    ds_read_b64_tr_b16 a[218:219], v202 offset:19456
    s_waitcnt vmcnt(12)
    v_mfma_f32_32x32x16_bf16 v[48:63], a[24:27], a[108:111], v[48:63]
    buffer_load_dwordx4 v[208:211], v221, s[40:43], s4 offen offset:3072 sc1
    v_mfma_f32_32x32x16_bf16 v[64:79], a[28:31], a[108:111], v[64:79]
    ds_read_b64_tr_b16 a[220:221], v234 offset:18432
    ds_read_b64_tr_b16 a[222:223], v234 offset:19456
    s_waitcnt vmcnt(11) lgkmcnt(15)
    v_mfma_f32_32x32x16_bf16 v[16:31], a[112:115], v[160:163], v[16:31]
    v_cmp_ne_u64 vcc, s[26:27], v[8:9]
    s_cbranch_vccnz L_pc3_slow
L_pc3_back:
    v_mfma_f32_32x32x16_bf16 v[32:47], a[116:119], v[160:163], v[32:47]
    s_waitcnt vmcnt(10)
    v_mfma_f32_32x32x16_bf16 v[48:63], a[112:115], v[164:167], v[48:63]
    v_mfma_f32_32x32x16_bf16 v[64:79], a[116:119], v[164:167], v[64:79]
    s_waitcnt vmcnt(9)
    v_mfma_f32_32x32x16_bf16 v[16:31], a[120:123], v[168:171], v[16:31]
    s_add_u32 s7, s5, 4096
    buffer_load_dwordx4 a[32:35], v220, s[40:43], s5 offen offset:0 sc1
    v_mfma_f32_32x32x16_bf16 v[32:47], a[124:127], v[168:171], v[32:47]
    buffer_load_dwordx4 a[40:43], v220, s[40:43], s5 offen offset:1024 sc1
    s_waitcnt vmcnt(10)
    v_mfma_f32_32x32x16_bf16 v[48:63], a[120:123], v[172:175], v[48:63]
    buffer_load_dwordx4 a[48:51], v220, s[40:43], s5 offen offset:2048 sc1
    v_mfma_f32_32x32x16_bf16 v[64:79], a[124:127], v[172:175], v[64:79]
    buffer_load_dwordx4 a[56:59], v220, s[40:43], s5 offen offset:3072 sc1
    s_waitcnt vmcnt(11)
    v_mfma_f32_32x32x16_bf16 v[16:31], a[128:131], v[176:179], v[16:31]
    buffer_load_dwordx4 v[80:83], v220, s[40:43], s7 offen offset:0 sc1
    v_mfma_f32_32x32x16_bf16 v[32:47], a[132:135], v[176:179], v[32:47]
    buffer_load_dwordx4 v[88:91], v220, s[40:43], s7 offen offset:1024 sc1
    s_waitcnt vmcnt(12)
    v_mfma_f32_32x32x16_bf16 v[48:63], a[128:131], v[180:183], v[48:63]
    buffer_load_dwordx4 v[96:99], v220, s[40:43], s7 offen offset:2048 sc1
    v_mfma_f32_32x32x16_bf16 v[64:79], a[132:135], v[180:183], v[64:79]
    s_waitcnt vmcnt(12)
    v_mfma_f32_32x32x16_bf16 v[16:31], a[136:139], v[184:187], v[16:31]
    buffer_load_dwordx4 v[104:107], v220, s[40:43], s7 offen offset:3072 sc1
    v_mfma_f32_32x32x16_bf16 v[32:47], a[140:143], v[184:187], v[32:47]
    buffer_load_dwordx4 a[36:39], v221, s[40:43], s5 offen offset:0 sc1
    s_waitcnt vmcnt(13)
    v_mfma_f32_32x32x16_bf16 v[48:63], a[136:139], v[188:191], v[48:63]
    buffer_load_dwordx4 a[44:47], v221, s[40:43], s5 offen offset:1024 sc1
    v_mfma_f32_32x32x16_bf16 v[64:79], a[140:143], v[188:191], v[64:79]
    s_waitcnt vmcnt(13)
    v_mfma_f32_32x32x16_bf16 v[16:31], a[144:147], v[192:195], v[16:31]
    buffer_load_dwordx4 a[52:55], v221, s[40:43], s5 offen offset:2048 sc1
    v_mfma_f32_32x32x16_bf16 v[32:47], a[148:151], v[192:195], v[32:47]
    buffer_load_dwordx4 a[60:63], v221, s[40:43], s5 offen offset:3072 sc1
    s_waitcnt vmcnt(13)
    v_mfma_f32_32x32x16_bf16 v[16:31], a[152:155], v[204:207], v[16:31]
    buffer_load_dwordx4 v[84:87], v221, s[40:43], s7 offen offset:0 sc1
    v_mfma_f32_32x32x16_bf16 v[32:47], a[156:159], v[204:207], v[32:47]
    v_mfma_f32_32x32x16_bf16 v[48:63], a[144:147], v[196:199], v[48:63]
    buffer_load_dwordx4 v[92:95], v221, s[40:43], s7 offen offset:1024 sc1
    v_mfma_f32_32x32x16_bf16 v[64:79], a[148:151], v[196:199], v[64:79]
    buffer_load_dwordx4 v[100:103], v221, s[40:43], s7 offen offset:2048 sc1
    s_nop 5
    v_mul_f32 v16, v222, v16
    v_mul_f32 v17, v222, v17
    v_mul_f32 v18, v222, v18
    v_mul_f32 v19, v222, v19
    v_mul_f32 v20, v222, v20
    v_mul_f32 v21, v222, v21
    v_mul_f32 v22, v222, v22
    v_mul_f32 v23, v222, v23
    v_mul_f32 v24, v222, v24
    v_mul_f32 v25, v222, v25
    s_waitcnt vmcnt(15)
    v_mfma_f32_32x32x16_bf16 v[48:63], a[152:155], v[208:211], v[48:63]
    buffer_load_dwordx4 v[108:111], v221, s[40:43], s7 offen offset:3072 sc1
    v_mul_f32 v26, v222, v26
    v_mul_f32 v27, v222, v27
    v_mul_f32 v28, v222, v28
    v_mul_f32 v29, v222, v29
    v_mul_f32 v30, v222, v30
    v_mul_f32 v31, v222, v31
    v_mul_f32 v32, v222, v32
    v_mul_f32 v33, v222, v33
    v_mul_f32 v34, v222, v34
    v_mul_f32 v35, v222, v35
    v_mul_f32 v36, v222, v36
    v_mfma_f32_32x32x16_bf16 v[64:79], a[156:159], v[208:211], v[64:79]
    v_mul_f32 v37, v222, v37
    v_mul_f32 v38, v222, v38
    v_mul_f32 v39, v222, v39
    v_mul_f32 v40, v222, v40
    v_mul_f32 v41, v222, v41
    v_mul_f32 v42, v222, v42
    v_mul_f32 v43, v222, v43
    v_mul_f32 v44, v222, v44
    v_mul_f32 v45, v222, v45
    v_mul_f32 v46, v222, v46
    v_mul_f32 v47, v222, v47
    ds_read_b128 v[112:115], v10 offset:0
    ds_read_b128 v[116:119], v10 offset:16
    ds_read_b128 v[120:123], v10 offset:64
    ds_read_b128 v[124:127], v10 offset:80
    s_waitcnt vmcnt(15)
    v_mfma_f32_32x32x16_bf16 v[16:31], a[160:163], a[32:35], v[16:31]
    v_mul_f32 v48, v223, v48
    v_mul_f32 v49, v223, v49
    v_mul_f32 v50, v223, v50
    v_mfma_f32_32x32x16_bf16 v[32:47], a[164:167], a[32:35], v[32:47]
    v_mul_f32 v51, v223, v51
    v_mul_f32 v52, v223, v52
    v_mul_f32 v53, v223, v53
    s_waitcnt vmcnt(14)
    v_mfma_f32_32x32x16_bf16 v[16:31], a[168:171], a[40:43], v[16:31]
    v_mul_f32 v54, v223, v54
    v_mul_f32 v55, v223, v55
    v_mul_f32 v56, v223, v56
    v_mfma_f32_32x32x16_bf16 v[32:47], a[172:175], a[40:43], v[32:47]
    v_mul_f32 v57, v223, v57
    v_mul_f32 v58, v223, v58
    v_mul_f32 v59, v223, v59
    s_waitcnt vmcnt(13)
    v_mfma_f32_32x32x16_bf16 v[16:31], a[176:179], a[48:51], v[16:31]
    v_mul_f32 v60, v223, v60
    v_mul_f32 v61, v223, v61
    v_mul_f32 v62, v223, v62
    v_mfma_f32_32x32x16_bf16 v[32:47], a[180:183], a[48:51], v[32:47]
    v_mul_f32 v63, v223, v63
    s_waitcnt lgkmcnt(3)
    v_add_f32 v64, v64, v112
    v_add_f32 v65, v65, v113
    s_waitcnt vmcnt(12)
    v_mfma_f32_32x32x16_bf16 v[16:31], a[184:187], a[56:59], v[16:31]
    v_add_f32 v66, v66, v114
    v_add_f32 v67, v67, v115
    s_waitcnt lgkmcnt(2)
    v_add_f32 v68, v68, v116
    v_mfma_f32_32x32x16_bf16 v[32:47], a[188:191], a[56:59], v[32:47]
    v_add_f32 v69, v69, v117
    v_add_f32 v70, v70, v118
    v_add_f32 v71, v71, v119
    s_waitcnt vmcnt(11)
    v_mfma_f32_32x32x16_bf16 v[16:31], a[192:195], v[80:83], v[16:31]
    s_waitcnt lgkmcnt(1)
    v_add_f32 v72, v72, v120
    v_add_f32 v73, v73, v121
    v_add_f32 v74, v74, v122
    v_mfma_f32_32x32x16_bf16 v[32:47], a[196:199], v[80:83], v[32:47]
    v_add_f32 v75, v75, v123
    s_waitcnt lgkmcnt(0)
    v_add_f32 v76, v76, v124
    v_add_f32 v77, v77, v125
    s_waitcnt vmcnt(10)
    v_mfma_f32_32x32x16_bf16 v[16:31], a[200:203], v[88:91], v[16:31]
    v_add_f32 v78, v78, v126
    v_add_f32 v79, v79, v127
    v_mul_f32 v64, v223, v64
    v_mfma_f32_32x32x16_bf16 v[32:47], a[204:207], v[88:91], v[32:47]
    v_mul_f32 v65, v223, v65
    v_mul_f32 v66, v223, v66
    v_mul_f32 v67, v223, v67
    s_waitcnt vmcnt(9)
    v_mfma_f32_32x32x16_bf16 v[16:31], a[208:211], v[96:99], v[16:31]
    v_mul_f32 v68, v223, v68
    v_mul_f32 v69, v223, v69
    v_mul_f32 v70, v223, v70
    v_mfma_f32_32x32x16_bf16 v[32:47], a[212:215], v[96:99], v[32:47]
    v_mul_f32 v71, v223, v71
    v_mul_f32 v72, v223, v72
    v_mul_f32 v73, v223, v73
    s_waitcnt vmcnt(8)
    v_mfma_f32_32x32x16_bf16 v[16:31], a[216:219], v[104:107], v[16:31]
    v_mul_f32 v74, v223, v74
    v_mul_f32 v75, v223, v75
    v_mul_f32 v76, v223, v76
    v_mfma_f32_32x32x16_bf16 v[32:47], a[220:223], v[104:107], v[32:47]
    v_mul_f32 v77, v223, v77
    v_mul_f32 v78, v223, v78
    v_mul_f32 v79, v223, v79
    s_waitcnt vmcnt(7)
    v_mfma_f32_32x32x16_bf16 v[48:63], a[160:163], a[36:39], v[48:63]
    s_waitcnt vmcnt(6)
    v_mfma_f32_32x32x16_bf16 v[48:63], a[168:171], a[44:47], v[48:63]
    s_waitcnt vmcnt(5)
    v_mfma_f32_32x32x16_bf16 v[48:63], a[176:179], a[52:55], v[48:63]
    ds_write_b128 v227, v[16:19] offset:32768
    ds_write_b128 v227, v[20:23] offset:33792
    s_waitcnt vmcnt(4)
    v_mfma_f32_32x32x16_bf16 v[48:63], a[184:187], a[60:63], v[48:63]
    ds_write_b128 v227, v[24:27] offset:34816
    ds_write_b128 v227, v[28:31] offset:35840
    s_waitcnt vmcnt(3)
    v_mfma_f32_32x32x16_bf16 v[48:63], a[192:195], v[84:87], v[48:63]
    ds_write_b128 v227, v[32:35] offset:0
    ds_write_b128 v227, v[36:39] offset:1024
    s_waitcnt vmcnt(2)
    v_mfma_f32_32x32x16_bf16 v[48:63], a[200:203], v[92:95], v[48:63]
    ds_write_b128 v227, v[40:43] offset:2048
    ds_write_b128 v227, v[44:47] offset:3072
    s_waitcnt vmcnt(1)
    v_mfma_f32_32x32x16_bf16 v[48:63], a[208:211], v[100:103], v[48:63]
    s_waitcnt vmcnt(0)
    v_mfma_f32_32x32x16_bf16 v[48:63], a[216:219], v[108:111], v[48:63]
    v_mfma_f32_32x32x16_bf16 v[64:79], a[164:167], a[36:39], v[64:79]
    v_mfma_f32_32x32x16_bf16 v[64:79], a[172:175], a[44:47], v[64:79]
    v_mfma_f32_32x32x16_bf16 v[64:79], a[180:183], a[52:55], v[64:79]
    v_mfma_f32_32x32x16_bf16 v[64:79], a[188:191], a[60:63], v[64:79]
    s_nop 7
    ds_write_b128 v227, v[48:51] offset:16384
    v_mfma_f32_32x32x16_bf16 v[64:79], a[196:199], v[84:87], v[64:79]
    ds_write_b128 v227, v[52:55] offset:17408
    v_mfma_f32_32x32x16_bf16 v[64:79], a[204:207], v[92:95], v[64:79]
    ds_write_b128 v227, v[56:59] offset:18432
    v_mfma_f32_32x32x16_bf16 v[64:79], a[212:215], v[100:103], v[64:79]
    ds_write_b128 v227, v[60:63] offset:19456
    v_mfma_f32_32x32x16_bf16 v[64:79], a[220:223], v[108:111], v[64:79]
    s_waitcnt lgkmcnt(0)
    s_barrier
    ds_read_b128 v[80:83], v224 offset:0
    ds_read_b128 v[84:87], v224 offset:1024
    ds_read_b128 v[88:91], v224 offset:2048
    ds_read_b128 v[92:95], v224 offset:3072
    ds_read_b128 v[96:99], v225 offset:0
    ds_read_b128 v[100:103], v225 offset:1024
    ds_read_b128 v[104:107], v225 offset:2048
    ds_read_b128 v[108:111], v225 offset:3072
    ds_read_b128 v[112:115], v226 offset:0
    ds_read_b128 v[116:119], v226 offset:1024
    ds_read_b128 v[120:123], v226 offset:2048
    ds_read_b128 v[124:127], v226 offset:3072
    s_waitcnt lgkmcnt(11)
    v_pk_add_f32 v[64:65], v[64:65], v[80:81]
    v_pk_add_f32 v[66:67], v[66:67], v[82:83]
    s_waitcnt lgkmcnt(10)
    v_pk_add_f32 v[68:69], v[68:69], v[84:85]
    v_pk_add_f32 v[70:71], v[70:71], v[86:87]
    s_waitcnt lgkmcnt(9)
    v_pk_add_f32 v[72:73], v[72:73], v[88:89]
    v_pk_add_f32 v[74:75], v[74:75], v[90:91]
    s_waitcnt lgkmcnt(8)
    v_pk_add_f32 v[76:77], v[76:77], v[92:93]
    v_pk_add_f32 v[78:79], v[78:79], v[94:95]
    s_waitcnt lgkmcnt(7)
    v_pk_add_f32 v[64:65], v[64:65], v[96:97]
    v_pk_add_f32 v[66:67], v[66:67], v[98:99]
    s_waitcnt lgkmcnt(6)
    v_pk_add_f32 v[68:69], v[68:69], v[100:101]
    v_pk_add_f32 v[70:71], v[70:71], v[102:103]
    s_waitcnt lgkmcnt(5)
    v_pk_add_f32 v[72:73], v[72:73], v[104:105]
    v_pk_add_f32 v[74:75], v[74:75], v[106:107]
    s_waitcnt lgkmcnt(4)
    v_pk_add_f32 v[76:77], v[76:77], v[108:109]
    v_pk_add_f32 v[78:79], v[78:79], v[110:111]
    s_waitcnt lgkmcnt(3)
    v_pk_add_f32 v[64:65], v[64:65], v[112:113]
    v_pk_add_f32 v[66:67], v[66:67], v[114:115]
    s_waitcnt lgkmcnt(2)
    v_pk_add_f32 v[68:69], v[68:69], v[116:117]
    v_pk_add_f32 v[70:71], v[70:71], v[118:119]
    s_waitcnt lgkmcnt(1)
    v_pk_add_f32 v[72:73], v[72:73], v[120:121]
    v_pk_add_f32 v[74:75], v[74:75], v[122:123]
    s_waitcnt lgkmcnt(0)
    v_pk_add_f32 v[76:77], v[76:77], v[124:125]
    v_pk_add_f32 v[78:79], v[78:79], v[126:127]
    v_cvt_pk_bf16_f32 v128, v64, v65
    v_cvt_pk_bf16_f32 v129, v66, v67
    v_cvt_pk_bf16_f32 v130, v68, v69
    v_cvt_pk_bf16_f32 v131, v70, v71
    v_cvt_pk_bf16_f32 v132, v72, v73
    v_cvt_pk_bf16_f32 v133, v74, v75
    v_cvt_pk_bf16_f32 v134, v76, v77
    v_cvt_pk_bf16_f32 v135, v78, v79
    buffer_store_dwordx4 v[128:131], v228, s[44:47], 0 offen offset:0
    buffer_store_dwordx4 v[132:135], v228, s[44:47], 0 offen offset:32
    s_endpgm
L_prep:
    v_lshlrev_b32 v2, 4, v1
    v_cmp_eq_u32 vcc, 0, v1
    v_mov_b32 v5, 0x7fff0000
    v_add_u32 v3, 0x1000, v2
    v_cndmask_b32_e64 v4, v5, 0, vcc
    s_lshl2_add_u32 s98, s10, s8
    s_mov_b32 s42, 16777216
    s_mov_b32 s43, 0x20000
    v_lshlrev_b32 v215, 7, v1
    s_mov_b32 s9, 1
    s_lshl_b32 s23, s3, 12
    v_lshrrev_b32 v11, 2, v1
    s_lshl2_add_u32 s56, s98, s3
    s_lshl_b32 s56, s56, 4
    v_add_u32 v20, s56, v11
    v_mul_u32_u24 v11, 896, v20
    v_and_b32 v12, 3, v1
    v_lshlrev_b32 v12, 4, v12
    v_add_u32 v11, v11, v12
    s_waitcnt lgkmcnt(0)
    s_load_dword s26, s[40:41], 0
    s_mov_b64 s[48:49], s[14:15]
    s_lshl2_add_u32 s63, s98, s3
    s_lshl_b32 s56, s63, 13
    s_add_u32 s57, s56, 0x100000
    s_mov_b32 s38, 1605632
    s_mov_b32 s39, 0x20000
    s_mov_b32 s50, 1605632
    s_mov_b32 s51, 0x20000
    s_mov_b32 s34, 401408
    s_mov_b32 s35, 0x20000
    s_mov_b64 s[32:33], s[20:21]
    s_nop 0
    buffer_load_dword v180, v215, s[36:39], s56 offen
    buffer_load_dword v181, v215, s[36:39], s57 offen
    buffer_load_dword v182, v215, s[48:51], s56 offen
    buffer_load_dword v183, v215, s[48:51], s57 offen
    buffer_load_dword v184, v215, s[32:35], s56 offen
    buffer_load_dwordx4 v[32:35], v11, s[28:31], 0 offen offset:0
    global_load_dwordx4 v[96:99], v12, s[18:19] offset:0
    buffer_load_dwordx4 v[36:39], v11, s[28:31], 0 offen offset:64
    global_load_dwordx4 v[100:103], v12, s[18:19] offset:64
    buffer_load_dwordx4 v[40:43], v11, s[28:31], 0 offen offset:128
    global_load_dwordx4 v[104:107], v12, s[18:19] offset:128
    buffer_load_dwordx4 v[44:47], v11, s[28:31], 0 offen offset:192
    global_load_dwordx4 v[108:111], v12, s[18:19] offset:192
    buffer_load_dwordx4 v[48:51], v11, s[28:31], 0 offen offset:256
    global_load_dwordx4 v[112:115], v12, s[18:19] offset:256
    buffer_load_dwordx4 v[52:55], v11, s[28:31], 0 offen offset:320
    global_load_dwordx4 v[116:119], v12, s[18:19] offset:320
    buffer_load_dwordx4 v[56:59], v11, s[28:31], 0 offen offset:384
    global_load_dwordx4 v[120:123], v12, s[18:19] offset:384
    buffer_load_dwordx4 v[60:63], v11, s[28:31], 0 offen offset:448
    global_load_dwordx4 v[124:127], v12, s[18:19] offset:448
    buffer_load_dwordx4 v[64:67], v11, s[28:31], 0 offen offset:512
    global_load_dwordx4 v[128:131], v12, s[18:19] offset:512
    buffer_load_dwordx4 v[68:71], v11, s[28:31], 0 offen offset:576
    global_load_dwordx4 v[132:135], v12, s[18:19] offset:576
    buffer_load_dwordx4 v[72:75], v11, s[28:31], 0 offen offset:640
    global_load_dwordx4 v[136:139], v12, s[18:19] offset:640
    buffer_load_dwordx4 v[76:79], v11, s[28:31], 0 offen offset:704
    global_load_dwordx4 v[140:143], v12, s[18:19] offset:704
    buffer_load_dwordx4 v[80:83], v11, s[28:31], 0 offen offset:768
    global_load_dwordx4 v[144:147], v12, s[18:19] offset:768
    buffer_load_dwordx4 v[84:87], v11, s[28:31], 0 offen offset:832
    global_load_dwordx4 v[148:151], v12, s[18:19] offset:832
    s_waitcnt lgkmcnt(0)
    s_mul_i32 s26, s26, 0x9e3779b1
    s_add_u32 s26, s26, 0x7f4a7c15
    s_xor_b32 s27, s26, 0x5bd1e995
    v_mov_b32 v6, s26
    v_mov_b32 v7, s27
    v_mov_b32 v24, 0
    v_mov_b32 v25, 0
    s_waitcnt vmcnt(26)
    v_dot2_f32_bf16 v24, v32, v96, v24
    v_dot2_f32_bf16 v25, v33, v97, v25
    v_dot2_f32_bf16 v24, v34, v98, v24
    v_dot2_f32_bf16 v25, v35, v99, v25
    s_waitcnt vmcnt(24)
    v_dot2_f32_bf16 v24, v36, v100, v24
    v_dot2_f32_bf16 v25, v37, v101, v25
    v_dot2_f32_bf16 v24, v38, v102, v24
    v_dot2_f32_bf16 v25, v39, v103, v25
    s_waitcnt vmcnt(22)
    v_dot2_f32_bf16 v24, v40, v104, v24
    v_dot2_f32_bf16 v25, v41, v105, v25
    v_dot2_f32_bf16 v24, v42, v106, v24
    v_dot2_f32_bf16 v25, v43, v107, v25
    s_waitcnt vmcnt(20)
    v_dot2_f32_bf16 v24, v44, v108, v24
    v_dot2_f32_bf16 v25, v45, v109, v25
    v_dot2_f32_bf16 v24, v46, v110, v24
    v_dot2_f32_bf16 v25, v47, v111, v25
    s_waitcnt vmcnt(18)
    v_dot2_f32_bf16 v24, v48, v112, v24
    v_dot2_f32_bf16 v25, v49, v113, v25
    v_dot2_f32_bf16 v24, v50, v114, v24
    v_dot2_f32_bf16 v25, v51, v115, v25
    s_waitcnt vmcnt(16)
    v_dot2_f32_bf16 v24, v52, v116, v24
    v_dot2_f32_bf16 v25, v53, v117, v25
    v_dot2_f32_bf16 v24, v54, v118, v24
    v_dot2_f32_bf16 v25, v55, v119, v25
    s_waitcnt vmcnt(14)
    v_dot2_f32_bf16 v24, v56, v120, v24
    v_dot2_f32_bf16 v25, v57, v121, v25
    v_dot2_f32_bf16 v24, v58, v122, v24
    v_dot2_f32_bf16 v25, v59, v123, v25
    s_waitcnt vmcnt(12)
    v_dot2_f32_bf16 v24, v60, v124, v24
    v_dot2_f32_bf16 v25, v61, v125, v25
    v_dot2_f32_bf16 v24, v62, v126, v24
    v_dot2_f32_bf16 v25, v63, v127, v25
    s_waitcnt vmcnt(10)
    v_dot2_f32_bf16 v24, v64, v128, v24
    v_dot2_f32_bf16 v25, v65, v129, v25
    v_dot2_f32_bf16 v24, v66, v130, v24
    v_dot2_f32_bf16 v25, v67, v131, v25
    s_waitcnt vmcnt(8)
    v_dot2_f32_bf16 v24, v68, v132, v24
    v_dot2_f32_bf16 v25, v69, v133, v25
    v_dot2_f32_bf16 v24, v70, v134, v24
    v_dot2_f32_bf16 v25, v71, v135, v25
    s_waitcnt vmcnt(6)
    v_dot2_f32_bf16 v24, v72, v136, v24
    v_dot2_f32_bf16 v25, v73, v137, v25
    v_dot2_f32_bf16 v24, v74, v138, v24
    v_dot2_f32_bf16 v25, v75, v139, v25
    s_waitcnt vmcnt(4)
    v_dot2_f32_bf16 v24, v76, v140, v24
    v_dot2_f32_bf16 v25, v77, v141, v25
    v_dot2_f32_bf16 v24, v78, v142, v24
    v_dot2_f32_bf16 v25, v79, v143, v25
    s_waitcnt vmcnt(2)
    v_dot2_f32_bf16 v24, v80, v144, v24
    v_dot2_f32_bf16 v25, v81, v145, v25
    v_dot2_f32_bf16 v24, v82, v146, v24
    v_dot2_f32_bf16 v25, v83, v147, v25
    s_waitcnt vmcnt(0)
    v_dot2_f32_bf16 v24, v84, v148, v24
    v_dot2_f32_bf16 v25, v85, v149, v25
    v_dot2_f32_bf16 v24, v86, v150, v24
    v_dot2_f32_bf16 v25, v87, v151, v25
    s_nop 2
    v_add_f32 v24, v24, v25
    s_nop 1
    v_add_f32_dpp v24, v24, v24 quad_perm:[1,0,3,2] row_mask:0xf bank_mask:0xf
    s_nop 1
    v_add_f32_dpp v24, v24, v24 quad_perm:[2,3,0,1] row_mask:0xf bank_mask:0xf
    v_mul_f32 v24, 0xbfb8aa3b, v24
    v_exp_f32 v24, v24
    s_nop 0
    v_add_f32 v24, 1.0, v24
    v_rcp_f32 v24, v24
    v_lshlrev_b32 v20, 2, v20
    v_and_b32 v25, 3, v1
    v_cmp_eq_u32 vcc, 0, v25
    v_mov_b32 v27, 0x7fff0000
    s_nop 0
    v_cndmask_b32 v20, v27, v20, vcc
    s_mov_b32 s56, 16384
    buffer_store_dword v24, v20, s[40:43], s56 offen sc1
    s_waitcnt vmcnt(0) lgkmcnt(0)
    s_barrier
    s_lshl_b32 s56, s98, 7
    s_add_u32 s56, s56, 4096
    s_cmp_eq_u32 s3, 0
    s_cbranch_scc0 L_prep_nf
    buffer_store_dwordx2 v[6:7], v4, s[40:43], s56 offen sc1
L_prep_nf:
    s_and_b32 s14, s11, 15
    s_lshr_b32 s100, s11, 4
    s_lshl1_add_u32 s100, s10, s100
    s_lshl2_add_u32 s15, s14, s3
    s_and_b32 s101, s100, 1
    s_lshl4_add_u32 s56, s15, s100
    s_lshl_b32 s56, s56, 7
    s_add_u32 s25, s56, 393216
    s_mul_i32 s58, s15, 148480
    s_lshl_b32 s59, s100, 11
    s_add_u32 s58, s58, s59
    s_add_u32 s18, s58, 6930432
    v_min_u32 v11, 13, v1
    v_lshrrev_b32 v12, 1, v11
    v_and_b32 v11, 1, v11
    s_mul_i32 s56, s100, 7
    s_lshr_b32 s56, s56, 1
    s_lshl_b32 s56, s56, 3
    v_mad_u32_u24 v11, v11, 31, s56
    v_mov_b32 v13, 896
    v_mov_b32 v14, 448
    v_subrev_u32 v15, 3, v12
    v_cmp_gt_u32 vcc, 3, v12
    s_nop 1
    v_cndmask_b32 v13, v13, v14, vcc
    v_cndmask_b32 v14, v15, v12, vcc
    s_mul_i32 s57, s3, 3
    s_lshl2_add_u32 s57, s14, s57
    s_sub_u32 s57, s57, 8
    v_add_u32 v14, s57, v14
    v_max_i32 v14, 0, v14
    v_mov_b32 v15, s15
    v_cmp_eq_u32 vcc, 6, v12
    s_nop 1
    v_cndmask_b32_e64 v13, v13, 0, vcc
    v_cndmask_b32 v14, v14, v15, vcc
    v_add_u32 v11, v11, v13
    v_mul_u32_u24 v11, 683, v11
    v_lshrrev_b32 v11, 16, v11
    v_lshl_add_u32 v11, v14, 4, v11
    v_lshlrev_b32 v11, 7, v11
    v_add_u32 v10, 131072, v11
    s_lshr_b32 s56, s15, 1
    s_lshl_b32 s56, s56, 7
    s_add_u32 s56, s56, 4096
    s_lshl_b32 s57, s98, 7
    s_add_u32 s57, s57, 4096
    v_writelane_b32 v10, s56, 14
    v_writelane_b32 v10, s57, 15
    s_mul_i32 s56, s100, 7
    s_lshr_b32 s56, s56, 1
    s_lshl_b32 s63, s56, 9
    s_add_u32 s57, s63, 28672
    v_add_u32 v247, s57, v2
    v_lshrrev_b32 v11, 5, v1
    v_and_b32 v12, 31, v1
    s_add_u32 s57, s63, 55296
    v_lshlrev_b32 v13, 2, v11
    v_xor_b32 v13, v13, v12
    v_lshlrev_b32 v13, 4, v13
    v_lshl_add_u32 v13, v11, 9, v13
    v_add_u32 v248, s57, v13
    v_xor_b32 v249, 128, v248
    v_add_u32 v244, s23, v2
    v_bfe_u32 v12, v1, 4, 1
    v_bfe_u32 v13, v1, 1, 1
    v_lshl_add_u32 v14, v12, 1, v13
    v_lshlrev_b32 v15, 9, v14
    v_xor_b32 v14, v14, v11
    v_lshl_add_u32 v15, v14, 6, v15
    v_bfe_u32 v14, v1, 2, 2
    v_lshl_add_u32 v15, v14, 4, v15
    v_and_b32 v14, 1, v1
    v_lshl_add_u32 v15, v14, 3, v15
    s_add_u32 s57, s23, 2048
    v_add_u32 v245, s57, v15
    v_xor_b32 v246, 128, v245
    v_and_b32 v12, 31, v1
    v_mul_u32_u24 v13, 12, v11
    s_cmp_eq_u32 s101, 0
    s_cselect_b32 s57, -1, 0
    s_cselect_b32 s58, 1544, 0
    v_and_b32 v13, s57, v13
    v_xor_b32 v12, v12, v13
    v_lshlrev_b32 v12, 4, v12
    v_lshl_add_u32 v12, v11, 11, v12
    s_mul_i32 s59, s3, 12288
    s_add_u32 s58, s58, s59
    v_add_u32 v250, s58, v12
    s_mul_i32 s57, s3, 3
    s_lshl2_add_u32 s57, s14, s57
    v_mov_b32 v12, 0x3f80
    s_add_u32 s58, s57, 0
    s_cmp_lt_u32 s58, 8
    s_cselect_b32 s58, 0xf14a, 0
    v_mov_b32 v251, s58
    s_add_u32 s58, s57, 1
    s_cmp_lt_u32 s58, 8
    s_cselect_b32 s58, 0xf14a, 0
    v_mov_b32 v252, s58
    s_add_u32 s58, s57, 2
    s_cmp_lt_u32 s58, 8
    s_cselect_b32 s58, 0xf14a, 0
    v_mov_b32 v253, s58
    v_cmp_gt_u32 vcc, 32, v1
    s_nop 1
    v_cndmask_b32 v251, v12, v251, vcc
    v_cndmask_b32 v252, v12, v252, vcc
    v_cndmask_b32 v253, v12, v253, vcc
    v_lshrrev_b32_e64 v12, 5, v1
    v_mul_u32_u24 v12, 36, v12
    v_sub_u32 v12, v1, v12
    v_cmp_le_i32_e64 s[64:65], 0, v12
    v_cmp_le_i32_e64 s[66:67], 1, v12
    v_cmp_le_i32_e64 s[68:69], 2, v12
    v_cmp_le_i32_e64 s[70:71], 3, v12
    v_cmp_le_i32_e64 s[72:73], 8, v12
    v_cmp_le_i32_e64 s[74:75], 9, v12
    v_cmp_le_i32_e64 s[76:77], 10, v12
    v_cmp_le_i32_e64 s[78:79], 11, v12
    v_cmp_le_i32_e64 s[80:81], 16, v12
    v_cmp_le_i32_e64 s[82:83], 17, v12
    v_cmp_le_i32_e64 s[84:85], 18, v12
    v_cmp_le_i32_e64 s[86:87], 19, v12
    v_cmp_le_i32_e64 s[88:89], 24, v12
    v_cmp_le_i32_e64 s[90:91], 25, v12
    v_cmp_le_i32_e64 s[92:93], 26, v12
    v_cmp_le_i32_e64 s[94:95], 27, v12
    v_mov_b32 v12, 0xffff
    v_mov_b32 v13, 0xffff0000
    v_cndmask_b32_e64 v14, 0, v12, s[64:65]
    v_cndmask_b32_e64 v15, 0, v13, s[66:67]
    v_or_b32 v236, v14, v15
    v_cndmask_b32_e64 v14, 0, v12, s[68:69]
    v_cndmask_b32_e64 v15, 0, v13, s[70:71]
    v_or_b32 v237, v14, v15
    v_cndmask_b32_e64 v14, 0, v12, s[72:73]
    v_cndmask_b32_e64 v15, 0, v13, s[74:75]
    v_or_b32 v238, v14, v15
    v_cndmask_b32_e64 v14, 0, v12, s[76:77]
    v_cndmask_b32_e64 v15, 0, v13, s[78:79]
    v_or_b32 v239, v14, v15
    v_cndmask_b32_e64 v14, 0, v12, s[80:81]
    v_cndmask_b32_e64 v15, 0, v13, s[82:83]
    v_or_b32 v240, v14, v15
    v_cndmask_b32_e64 v14, 0, v12, s[84:85]
    v_cndmask_b32_e64 v15, 0, v13, s[86:87]
    v_or_b32 v241, v14, v15
    v_cndmask_b32_e64 v14, 0, v12, s[88:89]
    v_cndmask_b32_e64 v15, 0, v13, s[90:91]
    v_or_b32 v242, v14, v15
    v_cndmask_b32_e64 v14, 0, v12, s[92:93]
    v_cndmask_b32_e64 v15, 0, v13, s[94:95]
    v_or_b32 v243, v14, v15
    s_mul_i32 s57, s3, 3
    s_lshl2_add_u32 s57, s14, s57
    s_add_i32 s58, s57, -8
    s_max_i32 s58, s58, 0
    s_mul_i32 s58, s58, 87040
    s_add_u32 s28, s58, 1048576
    s_add_i32 s58, s57, -7
    s_max_i32 s58, s58, 0
    s_mul_i32 s58, s58, 87040
    s_add_u32 s29, s58, 1048576
    s_add_i32 s58, s57, -6
    s_max_i32 s58, s58, 0
    s_mul_i32 s58, s58, 87040
    s_add_u32 s30, s58, 1048576
    s_mul_i32 s56, s100, 7
    s_lshr_b32 s56, s56, 1
    s_lshl_b32 s56, s56, 9
    s_mul_i32 s58, s15, 87040
    s_add_u32 s58, s58, s56
    s_add_u32 s31, s58, 1048576
    s_mov_b32 s60, 20000
L_poll4:
    buffer_load_dwordx2 v[8:9], v10, s[40:43], 0 offen sc1
    s_sub_u32 s60, s60, 1
    s_waitcnt vmcnt(0)
    v_cmp_ne_u64 vcc, s[26:27], v[8:9]
    s_cbranch_scc1 L_poll4_x
    s_cbranch_vccnz L_poll4
L_poll4_x:
    s_mul_i32 s59, s3, 12288
    s_add_u32 m0, s59, 0
    s_nop 0
    buffer_load_dwordx4 v247, s[40:43], s28 offen offset:0 sc1 lds
    buffer_load_dwordx4 v247, s[40:43], s28 offen offset:1024 sc1 lds
    buffer_load_dwordx4 v248, s[40:43], s28 offen offset:2048 sc1 lds
    buffer_load_dwordx4 v249, s[40:43], s28 offen offset:3072 sc1 lds
    s_add_u32 m0, s59, 4096
    s_nop 0
    buffer_load_dwordx4 v247, s[40:43], s29 offen offset:0 sc1 lds
    buffer_load_dwordx4 v247, s[40:43], s29 offen offset:1024 sc1 lds
    buffer_load_dwordx4 v248, s[40:43], s29 offen offset:2048 sc1 lds
    buffer_load_dwordx4 v249, s[40:43], s29 offen offset:3072 sc1 lds
    s_add_u32 m0, s59, 8192
    s_nop 0
    s_nop 0
    buffer_load_dwordx4 v247, s[40:43], s30 offen offset:0 sc1 lds
    buffer_load_dwordx4 v247, s[40:43], s30 offen offset:1024 sc1 lds
    buffer_load_dwordx4 v248, s[40:43], s30 offen offset:2048 sc1 lds
    buffer_load_dwordx4 v249, s[40:43], s30 offen offset:3072 sc1 lds
    buffer_load_dwordx4 v[16:19], v2, s[40:43], s31 offen offset:0 sc1
    buffer_load_dwordx4 v[20:23], v2, s[40:43], s31 offen offset:1024 sc1
    v_and_b32 v12, 31, v1
    v_lshlrev_b32 v12, 2, v12
    s_lshl_b32 s58, s15, 7
    s_add_u32 s58, s58, 16384
    buffer_load_dword v254, v12, s[40:43], s58 offen sc1
    s_waitcnt vmcnt(3)
    ds_write_b16 v250, v251 offset:0
    ds_write_b16 v250, v252 offset:4096
    ds_write_b16 v250, v253 offset:8192
    s_cmp_eq_u32 s101, 0
    s_cselect_b32 s56, 0, -1
    s_cselect_b32 s59, -1, 0
    s_mov_b32 s57, 0
    s_mov_b32 s58, 0
    v_mov_b32 v11, 0x3f80
    s_waitcnt vmcnt(2)
    v_cndmask_b32_e64 v16, v16, v11, s[56:57]
    v_cndmask_b32_e64 v17, v17, 0, s[56:57]
    s_waitcnt vmcnt(1)
    v_cndmask_b32_e64 v22, v22, v11, s[58:59]
    v_cndmask_b32_e64 v23, v23, 0, s[58:59]
    s_waitcnt lgkmcnt(0)
    s_barrier
    ds_read_b128 v[24:27], v244 offset:0
    ds_read_b128 v[28:31], v244 offset:1024
    ds_read_b128 v[32:35], v244 offset:32768
    ds_read_b128 v[36:39], v244 offset:33792
    s_waitcnt lgkmcnt(3)
    v_mfma_f32_32x32x16_bf16 v[56:71], v[24:27], v[16:19], 0
    s_waitcnt lgkmcnt(2)
    v_mfma_f32_32x32x16_bf16 v[56:71], v[28:31], v[20:23], v[56:71]
    ds_read_b128 v[24:27], v244 offset:4096
    ds_read_b128 v[28:31], v244 offset:5120
    s_waitcnt lgkmcnt(3)
    v_mfma_f32_32x32x16_bf16 v[72:87], v[32:35], v[16:19], 0
    s_waitcnt lgkmcnt(2)
    v_mfma_f32_32x32x16_bf16 v[72:87], v[36:39], v[20:23], v[72:87]
    ds_read_b128 v[32:35], v244 offset:8192
    ds_read_b128 v[36:39], v244 offset:9216
    s_waitcnt lgkmcnt(3)
    v_mfma_f32_32x32x16_bf16 v[88:103], v[24:27], v[16:19], 0
    s_waitcnt lgkmcnt(2)
    v_mfma_f32_32x32x16_bf16 v[88:103], v[28:31], v[20:23], v[88:103]
    ds_read_b128 v[24:27], v244 offset:12288
    ds_read_b128 v[28:31], v244 offset:13312
    s_waitcnt lgkmcnt(3)
    v_mfma_f32_32x32x16_bf16 v[120:135], v[32:35], v[16:19], 0
    s_nop 1
    s_nop 0
    v_cndmask_b32_e64 v72, v56, v72, s[64:65]
    v_cndmask_b32_e64 v73, v57, v73, s[66:67]
    v_cndmask_b32_e64 v74, v58, v74, s[68:69]
    v_cndmask_b32_e64 v75, v59, v75, s[70:71]
    v_cndmask_b32_e64 v76, v60, v76, s[72:73]
    v_cndmask_b32_e64 v77, v61, v77, s[74:75]
    v_cndmask_b32_e64 v78, v62, v78, s[76:77]
    v_cndmask_b32_e64 v79, v63, v79, s[78:79]
    s_waitcnt lgkmcnt(2)
    v_mfma_f32_32x32x16_bf16 v[120:135], v[36:39], v[20:23], v[120:135]
    s_nop 0
    ds_read_b128 v[32:35], v244 offset:16384
    ds_read_b128 v[36:39], v244 offset:17408
    v_cndmask_b32_e64 v80, v64, v80, s[80:81]
    v_cndmask_b32_e64 v81, v65, v81, s[82:83]
    v_cndmask_b32_e64 v82, v66, v82, s[84:85]
    v_cndmask_b32_e64 v83, v67, v83, s[86:87]
    v_cndmask_b32_e64 v84, v68, v84, s[88:89]
    v_cndmask_b32_e64 v85, v69, v85, s[90:91]
    v_cndmask_b32_e64 v86, v70, v86, s[92:93]
    v_cndmask_b32_e64 v87, v71, v87, s[94:95]
    s_waitcnt lgkmcnt(3)
    v_mfma_f32_32x32x16_bf16 v[56:71], v[24:27], v[16:19], 0
    v_max_f32 v5, v72, v73
    v_max3_f32 v5, v74, v75, v5
    v_max3_f32 v5, v76, v77, v5
    v_max3_f32 v5, v78, v79, v5
    v_max3_f32 v5, v80, v81, v5
    v_max3_f32 v5, v82, v83, v5
    v_max3_f32 v5, v84, v85, v5
    v_max3_f32 v5, v86, v87, v5
    s_waitcnt lgkmcnt(2)
    v_mfma_f32_32x32x16_bf16 v[56:71], v[28:31], v[20:23], v[56:71]
    s_nop 0
    ds_read_b128 v[24:27], v244 offset:20480
    ds_read_b128 v[28:31], v244 offset:21504
    v_max3_f32 v5, v88, v89, v5
    v_max3_f32 v5, v90, v91, v5
    v_max3_f32 v5, v92, v93, v5
    v_max3_f32 v5, v94, v95, v5
    v_max3_f32 v5, v96, v97, v5
    v_max3_f32 v5, v98, v99, v5
    v_max3_f32 v5, v100, v101, v5
    v_max3_f32 v5, v102, v103, v5
    s_waitcnt lgkmcnt(3)
    v_mfma_f32_32x32x16_bf16 v[88:103], v[32:35], v[16:19], 0
    v_max3_f32 v5, v120, v121, v5
    v_max3_f32 v5, v122, v123, v5
    v_max3_f32 v5, v124, v125, v5
    v_max3_f32 v5, v126, v127, v5
    s_waitcnt lgkmcnt(2)
    v_mfma_f32_32x32x16_bf16 v[88:103], v[36:39], v[20:23], v[88:103]
    ds_read_b128 v[32:35], v244 offset:24576
    ds_read_b128 v[36:39], v244 offset:25600
    v_max3_f32 v5, v128, v129, v5
    v_max3_f32 v5, v130, v131, v5
    v_max3_f32 v5, v132, v133, v5
    v_max3_f32 v5, v134, v135, v5
    s_waitcnt lgkmcnt(3)
    v_mfma_f32_32x32x16_bf16 v[120:135], v[24:27], v[16:19], 0
    v_max3_f32 v5, v56, v57, v5
    v_max3_f32 v5, v58, v59, v5
    v_max3_f32 v5, v60, v61, v5
    v_max3_f32 v5, v62, v63, v5
    s_waitcnt lgkmcnt(2)
    v_mfma_f32_32x32x16_bf16 v[120:135], v[28:31], v[20:23], v[120:135]
    ds_read_b128 v[24:27], v244 offset:28672
    ds_read_b128 v[28:31], v244 offset:29696
    v_max3_f32 v5, v64, v65, v5
    v_max3_f32 v5, v66, v67, v5
    v_max3_f32 v5, v68, v69, v5
    v_max3_f32 v5, v70, v71, v5
    s_waitcnt lgkmcnt(3)
    v_mfma_f32_32x32x16_bf16 v[56:71], v[32:35], v[16:19], 0
    v_max3_f32 v5, v88, v89, v5
    v_max3_f32 v5, v90, v91, v5
    v_max3_f32 v5, v92, v93, v5
    v_max3_f32 v5, v94, v95, v5
    s_waitcnt lgkmcnt(2)
    v_mfma_f32_32x32x16_bf16 v[56:71], v[36:39], v[20:23], v[56:71]
    ds_read_b128 v[32:35], v244 offset:4096
    ds_read_b128 v[36:39], v244 offset:5120
    v_max3_f32 v5, v96, v97, v5
    v_max3_f32 v5, v98, v99, v5
    v_max3_f32 v5, v100, v101, v5
    v_max3_f32 v5, v102, v103, v5
    s_waitcnt lgkmcnt(3)
    v_mfma_f32_32x32x16_bf16 v[88:103], v[24:27], v[16:19], 0
    v_max3_f32 v5, v120, v121, v5
    v_max3_f32 v5, v122, v123, v5
    v_max3_f32 v5, v124, v125, v5
    v_max3_f32 v5, v126, v127, v5
    s_waitcnt lgkmcnt(2)
    v_mfma_f32_32x32x16_bf16 v[88:103], v[28:31], v[20:23], v[88:103]
    ds_read_b128 v[24:27], v244 offset:8192
    ds_read_b128 v[28:31], v244 offset:9216
    ds_read_b64_tr_b16 v[40:41], v245 offset:0
    ds_read_b64_tr_b16 v[42:43], v246 offset:0
    ds_read_b64_tr_b16 v[44:45], v245 offset:256
    ds_read_b64_tr_b16 v[46:47], v246 offset:256
    ds_read_b64_tr_b16 v[48:49], v245 offset:32768
    ds_read_b64_tr_b16 v[50:51], v246 offset:32768
    ds_read_b64_tr_b16 v[52:53], v245 offset:33024
    ds_read_b64_tr_b16 v[54:55], v246 offset:33024
    v_max3_f32 v5, v128, v129, v5
    v_max3_f32 v5, v130, v131, v5
    v_max3_f32 v5, v132, v133, v5
    v_max3_f32 v5, v134, v135, v5
    v_max3_f32 v5, v56, v57, v5
    v_max3_f32 v5, v58, v59, v5
    v_max3_f32 v5, v60, v61, v5
    v_max3_f32 v5, v62, v63, v5
    v_max3_f32 v5, v64, v65, v5
    v_max3_f32 v5, v66, v67, v5
    v_max3_f32 v5, v68, v69, v5
    v_max3_f32 v5, v70, v71, v5
    v_max3_f32 v5, v88, v89, v5
    v_max3_f32 v5, v90, v91, v5
    v_max3_f32 v5, v92, v93, v5
    v_max3_f32 v5, v94, v95, v5
    v_max3_f32 v5, v96, v97, v5
    v_max3_f32 v5, v98, v99, v5
    v_max3_f32 v5, v100, v101, v5
    v_max3_f32 v5, v102, v103, v5
    v_mov_b32 v11, v5
    s_nop 1
    v_permlane32_swap_b32 v5, v11
    v_max_f32 v5, v5, v11
    v_sub_f32 v104, 0, v5
    v_sub_f32 v105, 0, v5
    v_mov_b64 v[106:107], v[104:105]
    v_mov_b64 v[108:109], v[104:105]
    v_mov_b64 v[110:111], v[104:105]
    v_mov_b64 v[112:113], v[104:105]
    v_mov_b64 v[114:115], v[104:105]
    v_mov_b64 v[116:117], v[104:105]
    v_mov_b64 v[118:119], v[104:105]
    s_waitcnt lgkmcnt(11)
    s_nop 0
    v_mfma_f32_32x32x16_bf16 v[56:71], v[32:35], v[16:19], v[104:119]
    v_sub_f32 v72, v72, v5
    v_sub_f32 v73, v73, v5
    v_sub_f32 v74, v74, v5
    v_sub_f32 v75, v75, v5
    v_sub_f32 v76, v76, v5
    v_sub_f32 v77, v77, v5
    v_sub_f32 v78, v78, v5
    v_sub_f32 v79, v79, v5
    s_waitcnt lgkmcnt(10)
    v_mfma_f32_32x32x16_bf16 v[56:71], v[36:39], v[20:23], v[56:71]
    ds_read_b128 v[32:35], v244 offset:12288
    ds_read_b128 v[36:39], v244 offset:13312
    v_sub_f32 v80, v80, v5
    v_sub_f32 v81, v81, v5
    v_sub_f32 v82, v82, v5
    v_sub_f32 v83, v83, v5
    v_sub_f32 v84, v84, v5
    v_sub_f32 v85, v85, v5
    v_sub_f32 v86, v86, v5
    v_sub_f32 v87, v87, v5
    s_waitcnt lgkmcnt(11)
    v_mfma_f32_32x32x16_bf16 v[88:103], v[24:27], v[16:19], v[104:119]
    v_exp_f32 v72, v72
    v_exp_f32 v73, v73
    v_exp_f32 v74, v74
    v_exp_f32 v75, v75
    v_cvt_pk_bf16_f32 v136, v72, v73
    s_waitcnt lgkmcnt(10)
    v_mfma_f32_32x32x16_bf16 v[88:103], v[28:31], v[20:23], v[88:103]
    ds_read_b128 v[24:27], v244 offset:16384
    ds_read_b128 v[28:31], v244 offset:17408
    v_exp_f32 v76, v76
    v_exp_f32 v77, v77
    v_cvt_pk_bf16_f32 v137, v74, v75
    v_exp_f32 v78, v78
    v_exp_f32 v79, v79
    v_cvt_pk_bf16_f32 v138, v76, v77
    v_exp_f32 v80, v80
    v_exp_f32 v81, v81
    v_cvt_pk_bf16_f32 v139, v78, v79
    v_exp_f32 v82, v82
    v_exp_f32 v83, v83
    v_cvt_pk_bf16_f32 v140, v80, v81
    v_exp_f32 v84, v84
    v_exp_f32 v85, v85
    v_cvt_pk_bf16_f32 v141, v82, v83
    v_exp_f32 v86, v86
    v_exp_f32 v87, v87
    v_cvt_pk_bf16_f32 v142, v84, v85
    v_cvt_pk_bf16_f32 v143, v86, v87
    v_and_b32 v144, v136, v236
    v_xor_b32 v152, v136, v144
    v_and_b32 v145, v137, v237
    v_xor_b32 v153, v137, v145
    v_and_b32 v146, v138, v238
    v_xor_b32 v154, v138, v146
    v_and_b32 v147, v139, v239
    v_xor_b32 v155, v139, v147
    v_and_b32 v148, v140, v240
    v_xor_b32 v156, v140, v148
    v_and_b32 v149, v141, v241
    v_xor_b32 v157, v141, v149
    v_and_b32 v150, v142, v242
    v_xor_b32 v158, v142, v150
    v_and_b32 v151, v143, v243
    v_xor_b32 v159, v143, v151
    s_waitcnt lgkmcnt(10)
    v_mfma_f32_32x32x16_bf16 v[120:135], v[40:43], v[152:155], 0
    v_exp_f32 v56, v56
    v_exp_f32 v57, v57
    v_exp_f32 v58, v58
    v_exp_f32 v59, v59
    s_waitcnt lgkmcnt(8)
    v_mfma_f32_32x32x16_bf16 v[120:135], v[44:47], v[156:159], v[120:135]
    v_cvt_pk_bf16_f32 v136, v56, v57
    v_exp_f32 v60, v60
    v_exp_f32 v61, v61
    v_cvt_pk_bf16_f32 v137, v58, v59
    s_waitcnt lgkmcnt(6)
    v_mfma_f32_32x32x16_bf16 v[120:135], v[48:51], v[144:147], v[120:135]
    v_exp_f32 v62, v62
    v_exp_f32 v63, v63
    v_cvt_pk_bf16_f32 v138, v60, v61
    v_exp_f32_e64 v64, v64
    s_waitcnt lgkmcnt(4)
    v_mfma_f32_32x32x16_bf16 v[120:135], v[52:55], v[148:151], v[120:135]
    ds_read_b64_tr_b16 v[40:41], v245 offset:4096
    ds_read_b64_tr_b16 v[42:43], v246 offset:4096
    ds_read_b64_tr_b16 v[44:45], v245 offset:4352
    ds_read_b64_tr_b16 v[46:47], v246 offset:4352
    ds_read_b64_tr_b16 v[48:49], v245 offset:8192
    ds_read_b64_tr_b16 v[50:51], v246 offset:8192
    ds_read_b64_tr_b16 v[52:53], v245 offset:8448
    ds_read_b64_tr_b16 v[54:55], v246 offset:8448
    v_exp_f32 v65, v65
    v_cvt_pk_bf16_f32 v139, v62, v63
    v_exp_f32 v66, v66
    v_exp_f32 v67, v67
    s_waitcnt lgkmcnt(11)
    v_mfma_f32_32x32x16_bf16 v[72:87], v[32:35], v[16:19], v[104:119]
    v_cvt_pk_bf16_f32 v140, v64, v65
    v_exp_f32 v68, v68
    v_exp_f32 v69, v69
    v_cvt_pk_bf16_f32 v141, v66, v67
    s_waitcnt lgkmcnt(10)
    v_mfma_f32_32x32x16_bf16 v[72:87], v[36:39], v[20:23], v[72:87]
    ds_read_b128 v[32:35], v244 offset:20480
    ds_read_b128 v[36:39], v244 offset:21504
    v_exp_f32 v70, v70
    v_exp_f32 v71, v71
    v_cvt_pk_bf16_f32 v142, v68, v69
    v_cvt_pk_bf16_f32 v143, v70, v71
    s_waitcnt lgkmcnt(8)
    v_mfma_f32_32x32x16_bf16 v[120:135], v[40:43], v[136:139], v[120:135]
    v_exp_f32 v88, v88
    v_exp_f32 v89, v89
    v_exp_f32 v90, v90
    v_exp_f32 v91, v91
    v_cvt_pk_bf16_f32 v152, v88, v89
    v_exp_f32 v92, v92
    s_waitcnt lgkmcnt(6)
    v_mfma_f32_32x32x16_bf16 v[120:135], v[44:47], v[140:143], v[120:135]
    ds_read_b64_tr_b16 v[40:41], v245 offset:12288
    ds_read_b64_tr_b16 v[42:43], v246 offset:12288
    ds_read_b64_tr_b16 v[44:45], v245 offset:12544
    ds_read_b64_tr_b16 v[46:47], v246 offset:12544
    v_exp_f32 v93, v93
    v_cvt_pk_bf16_f32 v153, v90, v91
    v_exp_f32 v94, v94
    v_exp_f32 v95, v95
    v_cvt_pk_bf16_f32 v154, v92, v93
    v_exp_f32 v96, v96
    v_mfma_f32_32x32x16_bf16 v[56:71], v[24:27], v[16:19], v[104:119]
    v_exp_f32 v97, v97
    v_cvt_pk_bf16_f32 v155, v94, v95
    v_exp_f32 v98, v98
    v_exp_f32 v99, v99
    v_cvt_pk_bf16_f32 v156, v96, v97
    v_exp_f32 v100, v100
    v_mfma_f32_32x32x16_bf16 v[56:71], v[28:31], v[20:23], v[56:71]
    ds_read_b128 v[24:27], v244 offset:24576
    ds_read_b128 v[28:31], v244 offset:25600
    v_exp_f32 v101, v101
    v_cvt_pk_bf16_f32 v157, v98, v99
    v_exp_f32 v102, v102
    v_exp_f32 v103, v103
    v_cvt_pk_bf16_f32 v158, v100, v101
    v_cvt_pk_bf16_f32 v159, v102, v103
    s_waitcnt lgkmcnt(10)
    v_mfma_f32_32x32x16_bf16 v[120:135], v[48:51], v[152:155], v[120:135]
    v_exp_f32 v72, v72
    v_exp_f32 v73, v73
    v_exp_f32 v74, v74
    v_exp_f32 v75, v75
    v_cvt_pk_bf16_f32 v136, v72, v73
    v_exp_f32 v76, v76
    s_waitcnt lgkmcnt(8)
    v_mfma_f32_32x32x16_bf16 v[120:135], v[52:55], v[156:159], v[120:135]
    ds_read_b64_tr_b16 v[48:49], v245 offset:16384
    ds_read_b64_tr_b16 v[50:51], v246 offset:16384
    ds_read_b64_tr_b16 v[52:53], v245 offset:16640
    ds_read_b64_tr_b16 v[54:55], v246 offset:16640
    v_exp_f32 v77, v77
    v_cvt_pk_bf16_f32 v137, v74, v75
    v_exp_f32 v78, v78
    v_exp_f32 v79, v79
    v_cvt_pk_bf16_f32 v138, v76, v77
    v_exp_f32 v80, v80
    s_waitcnt lgkmcnt(11)
    v_mfma_f32_32x32x16_bf16 v[88:103], v[32:35], v[16:19], v[104:119]
    v_exp_f32 v81, v81
    v_cvt_pk_bf16_f32 v139, v78, v79
    v_exp_f32 v82, v82
    v_exp_f32 v83, v83
    v_cvt_pk_bf16_f32 v140, v80, v81
    v_exp_f32 v84, v84
    s_waitcnt lgkmcnt(10)
    v_mfma_f32_32x32x16_bf16 v[88:103], v[36:39], v[20:23], v[88:103]
    ds_read_b128 v[32:35], v244 offset:28672
    ds_read_b128 v[36:39], v244 offset:29696
    v_exp_f32 v85, v85
    v_cvt_pk_bf16_f32 v141, v82, v83
    v_exp_f32 v86, v86
    v_exp_f32 v87, v87
    v_cvt_pk_bf16_f32 v142, v84, v85
    v_cvt_pk_bf16_f32 v143, v86, v87
    s_waitcnt lgkmcnt(10)
    v_mfma_f32_32x32x16_bf16 v[120:135], v[40:43], v[136:139], v[120:135]
    v_exp_f32 v56, v56
    v_exp_f32 v57, v57
    v_exp_f32 v58, v58
    v_exp_f32 v59, v59
    v_cvt_pk_bf16_f32 v144, v56, v57
    v_exp_f32 v60, v60
    s_waitcnt lgkmcnt(8)
    v_mfma_f32_32x32x16_bf16 v[120:135], v[44:47], v[140:143], v[120:135]
    ds_read_b64_tr_b16 v[40:41], v245 offset:20480
    ds_read_b64_tr_b16 v[42:43], v246 offset:20480
    ds_read_b64_tr_b16 v[44:45], v245 offset:20736
    ds_read_b64_tr_b16 v[46:47], v246 offset:20736
    v_exp_f32 v61, v61
    v_cvt_pk_bf16_f32 v145, v58, v59
    v_exp_f32 v62, v62
    v_exp_f32 v63, v63
    v_cvt_pk_bf16_f32 v146, v60, v61
    v_exp_f32 v64, v64
    s_waitcnt lgkmcnt(11)
    v_mfma_f32_32x32x16_bf16 v[72:87], v[24:27], v[16:19], v[104:119]
    v_exp_f32 v65, v65
    v_cvt_pk_bf16_f32 v147, v62, v63
    v_exp_f32 v66, v66
    v_exp_f32 v67, v67
    v_cvt_pk_bf16_f32 v148, v64, v65
    v_exp_f32 v68, v68
    s_waitcnt lgkmcnt(10)
    v_mfma_f32_32x32x16_bf16 v[72:87], v[28:31], v[20:23], v[72:87]
    v_exp_f32 v69, v69
    v_cvt_pk_bf16_f32 v149, v66, v67
    v_exp_f32 v70, v70
    v_exp_f32 v71, v71
    v_cvt_pk_bf16_f32 v150, v68, v69
    v_cvt_pk_bf16_f32 v151, v70, v71
    s_waitcnt lgkmcnt(8)
    v_mfma_f32_32x32x16_bf16 v[120:135], v[48:51], v[144:147], v[120:135]
    v_exp_f32 v88, v88
    v_exp_f32 v89, v89
    v_exp_f32 v90, v90
    v_exp_f32 v91, v91
    v_cvt_pk_bf16_f32 v136, v88, v89
    v_exp_f32 v92, v92
    s_waitcnt lgkmcnt(6)
    v_mfma_f32_32x32x16_bf16 v[120:135], v[52:55], v[148:151], v[120:135]
    ds_read_b64_tr_b16 v[48:49], v245 offset:24576
    ds_read_b64_tr_b16 v[50:51], v246 offset:24576
    ds_read_b64_tr_b16 v[52:53], v245 offset:24832
    ds_read_b64_tr_b16 v[54:55], v246 offset:24832
    v_exp_f32 v93, v93
    v_cvt_pk_bf16_f32 v137, v90, v91
    v_exp_f32 v94, v94
    v_exp_f32 v95, v95
    v_cvt_pk_bf16_f32 v138, v92, v93
    v_exp_f32 v96, v96
    s_waitcnt lgkmcnt(9)
    v_mfma_f32_32x32x16_bf16 v[56:71], v[32:35], v[16:19], v[104:119]
    v_exp_f32 v97, v97
    v_cvt_pk_bf16_f32 v139, v94, v95
    v_exp_f32 v98, v98
    v_exp_f32 v99, v99
    v_cvt_pk_bf16_f32 v140, v96, v97
    v_exp_f32 v100, v100
    s_waitcnt lgkmcnt(8)
    v_mfma_f32_32x32x16_bf16 v[56:71], v[36:39], v[20:23], v[56:71]
    v_exp_f32 v101, v101
    v_cvt_pk_bf16_f32 v141, v98, v99
    v_exp_f32 v102, v102
    v_exp_f32 v103, v103
    v_cvt_pk_bf16_f32 v142, v100, v101
    v_cvt_pk_bf16_f32 v143, v102, v103
    s_waitcnt lgkmcnt(6)
    v_mfma_f32_32x32x16_bf16 v[120:135], v[40:43], v[136:139], v[120:135]
    v_exp_f32 v72, v72
    v_exp_f32 v73, v73
    v_exp_f32 v74, v74
    v_exp_f32 v75, v75
    v_cvt_pk_bf16_f32 v144, v72, v73
    v_exp_f32 v76, v76
    v_exp_f32 v77, v77
    v_cvt_pk_bf16_f32 v145, v74, v75
    v_exp_f32 v78, v78
    v_exp_f32 v79, v79
    v_cvt_pk_bf16_f32 v146, v76, v77
    v_exp_f32 v80, v80
    s_waitcnt lgkmcnt(4)
    v_mfma_f32_32x32x16_bf16 v[120:135], v[44:47], v[140:143], v[120:135]
    ds_read_b64_tr_b16 v[40:41], v245 offset:28672
    ds_read_b64_tr_b16 v[42:43], v246 offset:28672
    ds_read_b64_tr_b16 v[44:45], v245 offset:28928
    ds_read_b64_tr_b16 v[46:47], v246 offset:28928
    v_exp_f32 v81, v81
    v_cvt_pk_bf16_f32 v147, v78, v79
    v_exp_f32 v82, v82
    v_exp_f32 v83, v83
    v_cvt_pk_bf16_f32 v148, v80, v81
    v_exp_f32 v84, v84
    v_exp_f32 v85, v85
    v_cvt_pk_bf16_f32 v149, v82, v83
    v_exp_f32 v86, v86
    v_exp_f32 v87, v87
    v_cvt_pk_bf16_f32 v150, v84, v85
    v_cvt_pk_bf16_f32 v151, v86, v87
    s_waitcnt lgkmcnt(6)
    v_mfma_f32_32x32x16_bf16 v[120:135], v[48:51], v[144:147], v[120:135]
    v_exp_f32 v56, v56
    v_exp_f32 v57, v57
    v_exp_f32 v58, v58
    v_exp_f32 v59, v59
    v_cvt_pk_bf16_f32 v136, v56, v57
    v_exp_f32 v60, v60
    v_exp_f32 v61, v61
    v_cvt_pk_bf16_f32 v137, v58, v59
    v_exp_f32 v62, v62
    v_exp_f32 v63, v63
    v_cvt_pk_bf16_f32 v138, v60, v61
    v_exp_f32 v64, v64
    s_waitcnt lgkmcnt(4)
    v_mfma_f32_32x32x16_bf16 v[120:135], v[52:55], v[148:151], v[120:135]
    v_exp_f32 v65, v65
    v_cvt_pk_bf16_f32 v139, v62, v63
    v_exp_f32 v66, v66
    v_exp_f32 v67, v67
    v_cvt_pk_bf16_f32 v140, v64, v65
    v_exp_f32 v68, v68
    v_exp_f32 v69, v69
    v_cvt_pk_bf16_f32 v141, v66, v67
    v_exp_f32 v70, v70
    v_exp_f32 v71, v71
    v_cvt_pk_bf16_f32 v142, v68, v69
    v_cvt_pk_bf16_f32 v143, v70, v71
    s_waitcnt lgkmcnt(2)
    v_mfma_f32_32x32x16_bf16 v[120:135], v[40:43], v[136:139], v[120:135]
    s_waitcnt lgkmcnt(0)
    v_mfma_f32_32x32x16_bf16 v[120:135], v[44:47], v[140:143], v[120:135]
    s_cmp_eq_u32 s101, 0
    s_cselect_b64 s[56:57], -1, 0
    s_cselect_b32 s64, 0, -1
    s_cselect_b32 s67, -1, 0
    s_mov_b32 s65, 0
    s_mov_b32 s66, 0
    s_nop 5
    v_cndmask_b32_e64 v11, v120, v132, s[56:57]
    v_mov_b32 v12, v11
    s_nop 1
    v_permlane32_swap_b32 v11, v12
    v_cndmask_b32_e64 v11, v11, v12, s[56:57]
    v_rcp_f32 v11, v11
    s_waitcnt vmcnt(0)
    v_mul_f32 v12, v11, v254
    v_mul_f32 v120, v12, v120
    v_mul_f32 v121, v12, v121
    v_mul_f32 v122, v12, v122
    v_mul_f32 v123, v12, v123
    v_mul_f32 v124, v12, v124
    v_mul_f32 v125, v12, v125
    v_mul_f32 v126, v12, v126
    v_mul_f32 v127, v12, v127
    v_cvt_pk_bf16_f32 v136, v120, v121
    v_cvt_pk_bf16_f32 v137, v122, v123
    v_cvt_pk_bf16_f32 v138, v124, v125
    v_cvt_pk_bf16_f32 v139, v126, v127
    v_cndmask_b32_e64 v136, v136, 0, s[64:65]
    v_cndmask_b32_e64 v137, v137, 0, s[64:65]
    buffer_store_dwordx4 v[136:139], v2, s[40:43], s18 offen offset:0 sc1
    v_mul_f32 v128, v12, v128
    v_mul_f32 v129, v12, v129
    v_mul_f32 v130, v12, v130
    v_mul_f32 v131, v12, v131
    v_mul_f32 v132, v12, v132
    v_mul_f32 v133, v12, v133
    v_mul_f32 v134, v12, v134
    v_mul_f32 v135, v12, v135
    v_cvt_pk_bf16_f32 v140, v128, v129
    v_cvt_pk_bf16_f32 v141, v130, v131
    v_cvt_pk_bf16_f32 v142, v132, v133
    v_cvt_pk_bf16_f32 v143, v134, v135
    v_cndmask_b32_e64 v142, v142, 0, s[66:67]
    v_cndmask_b32_e64 v143, v143, 0, s[66:67]
    buffer_store_dwordx4 v[140:143], v2, s[40:43], s18 offen offset:1024 sc1
    s_waitcnt vmcnt(0)
    buffer_store_dwordx2 v[6:7], v4, s[40:43], s25 offen sc1
    s_cmp_eq_u32 s2, 56
    s_cbranch_scc0 L_end
    s_cmp_eq_u32 s3, 0
    s_cbranch_scc0 L_end
    v_lshlrev_b32 v10, 7, v1
    s_mov_b32 s60, 20000
L_ep:
    s_mov_b32 s56, 393216
    buffer_load_dwordx2 v[16:17], v10, s[40:43], s56 offen sc1
    s_mov_b32 s56, 401408
    buffer_load_dwordx2 v[18:19], v10, s[40:43], s56 offen sc1
    s_mov_b32 s56, 409600
    buffer_load_dwordx2 v[20:21], v10, s[40:43], s56 offen sc1
    s_mov_b32 s56, 417792
    buffer_load_dwordx2 v[22:23], v10, s[40:43], s56 offen sc1
    s_mov_b32 s56, 425984
    buffer_load_dwordx2 v[24:25], v10, s[40:43], s56 offen sc1
    s_mov_b32 s56, 434176
    buffer_load_dwordx2 v[26:27], v10, s[40:43], s56 offen sc1
    s_mov_b32 s56, 442368
    buffer_load_dwordx2 v[28:29], v10, s[40:43], s56 offen sc1
    s_mov_b32 s56, 450560
    buffer_load_dwordx2 v[30:31], v10, s[40:43], s56 offen sc1
    s_mov_b32 s56, 458752
    buffer_load_dwordx2 v[32:33], v10, s[40:43], s56 offen sc1
    s_mov_b32 s56, 466944
    buffer_load_dwordx2 v[34:35], v10, s[40:43], s56 offen sc1
    s_mov_b32 s56, 475136
    buffer_load_dwordx2 v[36:37], v10, s[40:43], s56 offen sc1
    s_mov_b32 s56, 483328
    buffer_load_dwordx2 v[38:39], v10, s[40:43], s56 offen sc1
    s_mov_b32 s56, 491520
    buffer_load_dwordx2 v[40:41], v10, s[40:43], s56 offen sc1
    s_mov_b32 s56, 499712
    buffer_load_dwordx2 v[42:43], v10, s[40:43], s56 offen sc1
    s_mov_b32 s56, 507904
    buffer_load_dwordx2 v[44:45], v10, s[40:43], s56 offen sc1
    s_mov_b32 s56, 516096
    buffer_load_dwordx2 v[46:47], v10, s[40:43], s56 offen sc1
    s_waitcnt vmcnt(0)
    s_mov_b64 s[56:57], 0
    v_cmp_ne_u64 vcc, s[26:27], v[16:17]
    s_nop 0
    s_or_b64 s[56:57], s[56:57], vcc
    v_cmp_ne_u64 vcc, s[26:27], v[18:19]
    s_nop 0
    s_or_b64 s[56:57], s[56:57], vcc
    v_cmp_ne_u64 vcc, s[26:27], v[20:21]
    s_nop 0
    s_or_b64 s[56:57], s[56:57], vcc
    v_cmp_ne_u64 vcc, s[26:27], v[22:23]
    s_nop 0
    s_or_b64 s[56:57], s[56:57], vcc
    v_cmp_ne_u64 vcc, s[26:27], v[24:25]
    s_nop 0
    s_or_b64 s[56:57], s[56:57], vcc
    v_cmp_ne_u64 vcc, s[26:27], v[26:27]
    s_nop 0
    s_or_b64 s[56:57], s[56:57], vcc
    v_cmp_ne_u64 vcc, s[26:27], v[28:29]
    s_nop 0
    s_or_b64 s[56:57], s[56:57], vcc
    v_cmp_ne_u64 vcc, s[26:27], v[30:31]
    s_nop 0
    s_or_b64 s[56:57], s[56:57], vcc
    v_cmp_ne_u64 vcc, s[26:27], v[32:33]
    s_nop 0
    s_or_b64 s[56:57], s[56:57], vcc
    v_cmp_ne_u64 vcc, s[26:27], v[34:35]
    s_nop 0
    s_or_b64 s[56:57], s[56:57], vcc
    v_cmp_ne_u64 vcc, s[26:27], v[36:37]
    s_nop 0
    s_or_b64 s[56:57], s[56:57], vcc
    v_cmp_ne_u64 vcc, s[26:27], v[38:39]
    s_nop 0
    s_or_b64 s[56:57], s[56:57], vcc
    v_cmp_ne_u64 vcc, s[26:27], v[40:41]
    s_nop 0
    s_or_b64 s[56:57], s[56:57], vcc
    v_cmp_ne_u64 vcc, s[26:27], v[42:43]
    s_nop 0
    s_or_b64 s[56:57], s[56:57], vcc
    v_cmp_ne_u64 vcc, s[26:27], v[44:45]
    s_nop 0
    s_or_b64 s[56:57], s[56:57], vcc
    v_cmp_ne_u64 vcc, s[26:27], v[46:47]
    s_nop 0
    s_or_b64 s[56:57], s[56:57], vcc
    s_sub_u32 s60, s60, 1
    s_cbranch_scc1 L_end
    s_cmp_eq_u64 s[56:57], 0
    s_cbranch_scc0 L_ep
    buffer_store_dword v6, v4, s[40:43], 0 offen sc1
L_end:
    s_endpgm
L_pc1_slow:
    s_mov_b32 s60, 20000
L_pc1_loop:
    buffer_load_dwordx2 v[8:9], v10, s[40:43], 0 offen sc1
    s_sub_u32 s60, s60, 1
    s_waitcnt vmcnt(0)
    v_cmp_ne_u64 vcc, s[26:27], v[8:9]
    s_cbranch_scc1 L_pc1_back
    s_cbranch_vccnz L_pc1_loop
    s_branch L_pc1_back
L_pc2_slow:
    s_mov_b32 s60, 20000
L_pc2_loop:
    buffer_load_dwordx2 v[8:9], v231, s[40:43], 0 offen sc1
    s_sub_u32 s60, s60, 1
    s_waitcnt vmcnt(0)
    v_cmp_ne_u64 vcc, s[26:27], v[8:9]
    s_cbranch_scc1 L_pc2_back
    s_cbranch_vccnz L_pc2_loop
    s_branch L_pc2_back
L_pc3_slow:
    s_mov_b32 s60, 20000
L_pc3_loop:
    buffer_load_dwordx2 v[8:9], v229, s[40:43], 0 offen sc1
    s_sub_u32 s60, s60, 1
    s_waitcnt vmcnt(0)
    v_cmp_ne_u64 vcc, s[26:27], v[8:9]
    s_cbranch_scc1 L_pc3_back
    s_cbranch_vccnz L_pc3_loop
    s_branch L_pc3_back
s_endpgm
.fill 2048, 4, 0xbf800000
.section .rodata,"a"
.p2align 6
.amdhsa_kernel gated_mix__sliding_block__dense_activation_gelu__prompt_kernel
  .amdhsa_next_free_vgpr 512
  .amdhsa_next_free_sgpr 102
  .amdhsa_accum_offset 256
  .amdhsa_group_segment_fixed_size 0
  .amdhsa_kernarg_size 96
  .amdhsa_user_sgpr_count 2
  .amdhsa_user_sgpr_kernarg_segment_ptr 1
  .amdhsa_system_sgpr_workgroup_id_x 1
.end_amdhsa_kernel
```
